```python
import torch

def _softmax(x, axis=-1):
    return torch.softmax(x, dim=axis)
def _gelu(x):
    return torch.nn.functional.gelu(x, approximate="tanh")
def _silu(x):
    return torch.nn.functional.silu(x)
def _sigmoid(x):
    return torch.sigmoid(x)
def _layernorm(x, axis=-1, eps=1e-5):
    m = x.mean(dim=axis, keepdim=True)
    v = x.var(dim=axis, keepdim=True, unbiased=False)
    return (x - m) / torch.sqrt(v + eps)
def _scatter_add(tgt, idx, src, axis=0):
    return tgt.clone().index_add_(axis, idx, src)
def _segment_sum(src, seg, n):
    out = torch.zeros((n,) + src.shape[1:], dtype=src.dtype)
    return out.index_add_(0, seg, src)
def _pad(x, pw):
    flat = tuple(v for pair in reversed(pw) for v in pair)
    return torch.nn.functional.pad(x, flat)

kernel_name = 'sequential_preLN__sliding_block_cached__dense_activation_silu__decode'

def setup_inputs():

    _w = (lambda a: (lambda t: t.to(torch.bfloat16) if t.is_floating_point() else t)(torch.as_tensor(a)))
    def _A_setup():
        B, Sq, D = 8, 1, 640
        Hq, Hkv, Sk, Dh = 32, 32, 4096, 192
        assert Hq % Hkv == 0, (Hq, Hkv)
        return {
            "x": _w((lambda *s: torch.randn(*s, dtype=torch.bfloat16) * 0.05)(B, Sq, D)),
            "k_cache": _w((lambda *s: torch.randn(*s, dtype=torch.bfloat16) * 3.2)(B, Hkv, Sk, Dh)),
            "v_cache": _w((lambda *s: torch.randn(*s, dtype=torch.bfloat16) * 0.8)(B, Hkv, Sk, Dh)),
            "wq": _w((lambda *s: torch.randn(*s, dtype=torch.bfloat16) * 3.2)(D, Hq * Dh) * (D ** -0.5)),
            "wo": _w((lambda *s: torch.randn(*s, dtype=torch.bfloat16) * 0.8)(Hq * Dh, D) * ((Hq * Dh) ** -0.5)),
        }
    _A_in = _A_setup()

    def _B_setup():
        B, S, D, F = 8, 1, 640, 1536
        return {
            "x": _w((lambda *s: torch.randn(*s, dtype=torch.bfloat16) * 0.05)(B, S, D)),
            "w1": _w((lambda *s: torch.randn(*s, dtype=torch.bfloat16) * 3.2)(D, F) * (D ** -0.5)),
            "w2": _w((lambda *s: torch.randn(*s, dtype=torch.bfloat16) * 0.4)(F, D) * (F ** -0.5)),
        }
    _B_in = _B_setup()

    return {
        "A_x": _A_in["x"],
        "A_k_cache": _A_in["k_cache"],
        "A_v_cache": _A_in["v_cache"],
        "A_wq": _A_in["wq"],
        "A_wo": _A_in["wo"],
        "B_x": _B_in["x"],
        "B_w1": _B_in["w1"],
        "B_w2": _B_in["w2"],
    }

def reference(A_x, A_k_cache, A_v_cache, A_wq, A_wo, B_x, B_w1, B_w2):
    def _A_ref(x, k_cache, v_cache, wq, wo):
        B, Sq, D = x.shape
        Hq, Dh = 32, 192
        Hkv, Sk = k_cache.shape[1], k_cache.shape[2]
        W = min(4096, max(256, Sk // 4))
        rep = Hq // Hkv
        q = (lambda x, *d: x.permute(*d))((x @ wq).reshape(B, Sq, Hq, Dh), 0, 2, 1, 3)
        k = (lambda x, n, axis: torch.repeat_interleave(x, n, dim=axis))(k_cache[:, :, Sk - W:, :], rep, axis=1)
        v = (lambda x, n, axis: torch.repeat_interleave(x, n, dim=axis))(v_cache[:, :, Sk - W:, :], rep, axis=1)
        scores = torch.einsum("bhqd,bhkd->bhqk", q, k) * (Dh ** -0.5)
        p = _softmax(scores, axis=-1)
        o = torch.einsum("bhqk,bhkd->bhqd", p, v)
        return (lambda x, *d: x.permute(*d))(o, 0, 2, 1, 3).reshape(B, Sq, Hq * Dh) @ wo

    def _B_ref(x, w1, w2):
        h = torch.einsum("bsd,df->bsf", x, w1)
        h = _silu(h)
        out = torch.einsum("bsf,fd->bsd", h, w2)
        return out

    x = A_x
    h = x + _A_ref(_layernorm(x, axis=-1), A_k_cache, A_v_cache, A_wq, A_wo)
    h2 = h + _B_ref(_layernorm(h, axis=-1), B_w1, B_w2)
    return h2
```

```asm
; @launch grid=(256,1,1) block=(512,1,1) lds=122592
.amdgcn_target "amdgcn-amd-amdhsa--gfx950"
.text
.globl sequential_preLN__sliding_block_cached__dense_activation_silu__decode_kernel
.p2align 12
.fill 832, 4, 0xbf810000
.p2align 8
.type sequential_preLN__sliding_block_cached__dense_activation_silu__decode_kernel,@function
sequential_preLN__sliding_block_cached__dense_activation_silu__decode_kernel:
    s_cmpk_ge_u32 s2, 0x100
    s_cbranch_scc1 L_end
    s_load_dwordx16 s[4:19], s[0:1], 0
    s_load_dwordx4 s[20:23], s[0:1], 64
    s_load_dwordx2 s[24:25], s[0:1], 80
    s_getpc_b64 s[68:69]
L_ipc:
    s_mov_b32 s70, L_last-L_ipc
    s_mov_b32 s71, 0x20000
    s_lshr_b32 s27, s2, 3
    s_lshl_b32 s63, s27, 10
    v_lshlrev_b32 v1, 1, v0
    buffer_load_ushort v255, v1, s[68:71], s63 offen
    v_readfirstlane_b32 s30, v0
    v_and_b32 v0, 63, v0
    s_and_b32 s26, s2, 7
    s_lshr_b32 s30, s30, 6
    v_and_b32 v1, 7, v0
    v_lshlrev_b32 v1, 4, v1
    v_lshrrev_b32 v6, 3, v0
    s_and_b32 s60, s27, 3
    s_lshl2_add_u32 s28, s26, s60
    s_lshr_b32 s29, s27, 2
    v_lshlrev_b32 v3, 4, v0
    v_lshrrev_b32 v2, 4, v0
    v_and_b32 v7, 1, v6
    v_lshl_add_u32 v2, v7, 2, v2
    s_cmp_ge_u32 s30, 4
    s_cbranch_scc1 L_helper
    s_lshl_b32 s60, s29, 5
    s_add_u32 s60, s60, s28
    s_lshl4_add_u32 s60, s60, s30
    s_add_u32 s60, s60, 12
    s_mov_b32 s34, 98304
    s_mul_i32 s60, s60, s34
    s_mul_i32 s84, s26, 4
    s_and_b32 s61, s27, 3
    s_mul_i32 s61, s61, 1
    s_add_u32 s84, s84, s61
    s_mul_i32 s61, s29, 4
    s_add_u32 s84, s84, s61
    s_and_b32 s84, s84, 31
    s_mulk_i32 s84, 3072
    v_mul_u32_u24 v12, 384, v6
    v_add_u32 v12, v12, v1
    s_mov_b32 s35, 0x20000
    s_waitcnt lgkmcnt(0)
    s_add_u32 s32, s6, s60
    s_addc_u32 s33, s7, 0
    buffer_load_dwordx4 v[64:67], v12, s[32:35], s84 offen offset:0 nt
    buffer_load_dwordx4 v[68:71], v12, s[32:35], s84 offen offset:128 nt
    buffer_load_dwordx4 v[72:75], v12, s[32:35], s84 offen offset:256 nt
    s_branch L_stream
L_helper:
    v_mov_b32 v8, 0
    v_mov_b32 v9, 0
    ds_write_b64 v8, v[8:9] offset:10792
    ds_write_b32 v8, v8 offset:10788
    ds_write_b64 v8, v[8:9] offset:10808
    v_lshlrev_b32 v10, 2, v1
    v_lshrrev_b32 v10, 4, v10
    ds_write_b32 v10, v8 offset:10816
    s_mov_b32 s80, 0x05040100
    s_mov_b32 s81, 0x07060302
    s_sub_u32 s65, s30, 5
    s_cmp_ge_u32 s27, 24
    s_cbranch_scc1 L_clear
    s_cmp_lg_u32 s30, 4
    s_cbranch_scc1 L_xld
    s_setprio 3
    s_cmp_ge_u32 s27, 12
    s_cselect_b32 s63, 1, 0
    s_mul_i32 s64, s63, 12
    s_sub_u32 s64, s27, s64
    s_mul_i32 s65, s63, 3932160
    s_mul_i32 s66, s26, 1536
    s_add_u32 s65, s65, s66
    s_lshl_b32 s66, s64, 7
    s_add_u32 s65, s65, s66
    v_mul_u32_u24 v7, 98304, v2
    v_add_u32 v7, v7, v1
    s_movk_i32 s66, 12288
    s_mov_b32 s67, 700416
    s_waitcnt lgkmcnt(0)
    s_mov_b64 s[44:45], s[10:11]
    s_mov_b32 s46, 7864320
    s_mov_b32 s47, 0x20000
    buffer_load_dwordx4 v[64:67], v7, s[44:47], s65 offen nt
    s_add_u32 s65, s65, s66
    buffer_load_dwordx4 v[68:71], v7, s[44:47], s65 offen nt
    s_add_u32 s65, s65, s66
    buffer_load_dwordx4 v[72:75], v7, s[44:47], s65 offen nt
    s_add_u32 s65, s65, s66
    buffer_load_dwordx4 v[76:79], v7, s[44:47], s65 offen nt
    s_add_u32 s65, s65, s66
    buffer_load_dwordx4 v[80:83], v7, s[44:47], s65 offen nt
    s_add_u32 s65, s65, s66
    buffer_load_dwordx4 v[84:87], v7, s[44:47], s65 offen nt
    s_add_u32 s65, s65, s66
    buffer_load_dwordx4 v[88:91], v7, s[44:47], s65 offen nt
    s_add_u32 s65, s65, s66
    buffer_load_dwordx4 v[92:95], v7, s[44:47], s65 offen nt
    s_add_u32 s65, s65, s67
    buffer_load_dwordx4 v[96:99], v7, s[44:47], s65 offen nt
    s_add_u32 s65, s65, s66
    buffer_load_dwordx4 v[100:103], v7, s[44:47], s65 offen nt
    s_add_u32 s65, s65, s66
    buffer_load_dwordx4 v[104:107], v7, s[44:47], s65 offen nt
    s_add_u32 s65, s65, s66
    buffer_load_dwordx4 v[108:111], v7, s[44:47], s65 offen nt
    s_add_u32 s65, s65, s66
    buffer_load_dwordx4 v[112:115], v7, s[44:47], s65 offen nt
    s_add_u32 s65, s65, s66
    buffer_load_dwordx4 v[116:119], v7, s[44:47], s65 offen nt
    s_add_u32 s65, s65, s66
    buffer_load_dwordx4 v[120:123], v7, s[44:47], s65 offen nt
    s_add_u32 s65, s65, s66
    buffer_load_dwordx4 v[124:127], v7, s[44:47], s65 offen nt
    s_add_u32 s65, s65, s67
    buffer_load_dwordx4 v[128:131], v7, s[44:47], s65 offen nt
    s_add_u32 s65, s65, s66
    buffer_load_dwordx4 v[132:135], v7, s[44:47], s65 offen nt
    s_add_u32 s65, s65, s66
    buffer_load_dwordx4 v[136:139], v7, s[44:47], s65 offen nt
    s_add_u32 s65, s65, s66
    buffer_load_dwordx4 v[140:143], v7, s[44:47], s65 offen nt
    s_add_u32 s65, s65, s66
    buffer_load_dwordx4 v[144:147], v7, s[44:47], s65 offen nt
    s_add_u32 s65, s65, s66
    buffer_load_dwordx4 v[148:151], v7, s[44:47], s65 offen nt
    s_add_u32 s65, s65, s66
    buffer_load_dwordx4 v[152:155], v7, s[44:47], s65 offen nt
    s_add_u32 s65, s65, s66
    buffer_load_dwordx4 v[156:159], v7, s[44:47], s65 offen nt
    s_add_u32 s65, s65, s67
    buffer_load_dwordx4 v[160:163], v7, s[44:47], s65 offen nt
    s_add_u32 s65, s65, s66
    buffer_load_dwordx4 v[164:167], v7, s[44:47], s65 offen nt
    s_add_u32 s65, s65, s66
    buffer_load_dwordx4 v[168:171], v7, s[44:47], s65 offen nt
    s_add_u32 s65, s65, s66
    buffer_load_dwordx4 v[172:175], v7, s[44:47], s65 offen nt
    s_add_u32 s65, s65, s66
    buffer_load_dwordx4 v[176:179], v7, s[44:47], s65 offen nt
    s_add_u32 s65, s65, s66
    buffer_load_dwordx4 v[180:183], v7, s[44:47], s65 offen nt
    s_add_u32 s65, s65, s66
    buffer_load_dwordx4 v[184:187], v7, s[44:47], s65 offen nt
    s_add_u32 s65, s65, s66
    buffer_load_dwordx4 v[188:191], v7, s[44:47], s65 offen nt
    s_add_u32 s65, s65, s67
    buffer_load_dwordx4 v[192:195], v7, s[44:47], s65 offen nt
    s_add_u32 s65, s65, s66
    buffer_load_dwordx4 v[196:199], v7, s[44:47], s65 offen nt
    s_add_u32 s65, s65, s66
    buffer_load_dwordx4 v[200:203], v7, s[44:47], s65 offen nt
    s_add_u32 s65, s65, s66
    buffer_load_dwordx4 v[204:207], v7, s[44:47], s65 offen nt
    s_add_u32 s65, s65, s66
    buffer_load_dwordx4 v[208:211], v7, s[44:47], s65 offen nt
    s_add_u32 s65, s65, s66
    buffer_load_dwordx4 v[212:215], v7, s[44:47], s65 offen nt
    s_add_u32 s65, s65, s66
    buffer_load_dwordx4 v[216:219], v7, s[44:47], s65 offen nt
    s_add_u32 s65, s65, s66
    buffer_load_dwordx4 v[220:223], v7, s[44:47], s65 offen nt
    s_barrier
    s_branch L_h0q
L_clear:
    v_mov_b32 v8, -1
    v_mov_b32 v9, -1
    v_mov_b32 v10, -1
    v_mov_b32 v11, -1
    s_sub_u32 s63, s2, 192
    s_lshl2_add_u32 s63, s63, s30
    s_sub_u32 s63, s63, 4
    s_mulk_i32 s63, 6144
    s_add_u32 s64, s63, 4096
    s_waitcnt lgkmcnt(0)
    s_mov_b64 s[44:45], s[24:25]
    s_mov_b32 s46, 1511424
    s_mov_b32 s47, 0x20000
    buffer_store_dwordx4 v[8:11], v3, s[44:47], s63 offen offset:0 sc1
    buffer_store_dwordx4 v[8:11], v3, s[44:47], s63 offen offset:1024 sc1
    buffer_store_dwordx4 v[8:11], v3, s[44:47], s63 offen offset:2048 sc1
    buffer_store_dwordx4 v[8:11], v3, s[44:47], s63 offen offset:3072 sc1
    buffer_store_dwordx4 v[8:11], v3, s[44:47], s64 offen offset:0 sc1
    buffer_store_dwordx4 v[8:11], v3, s[44:47], s64 offen offset:1024 sc1
    s_barrier
    s_mov_b64 s[48:49], s[24:25]
    s_mov_b32 s50, 1511424
    s_mov_b32 s51, 0x20000
    s_mov_b64 s[40:41], s[4:5]
    s_mov_b32 s42, 10240
    s_mov_b32 s43, 0x20000
    s_waitcnt vmcnt(0)
    s_cmp_eq_u32 s30, 4
    s_cbranch_scc1 L_h0c
    s_branch L_rowsdone
L_xld:
    s_mul_i32 s66, s65, 3840
    v_lshlrev_b32 v5, 2, v0
    s_waitcnt lgkmcnt(0)
    s_mov_b64 s[48:49], s[24:25]
    s_mov_b32 s50, 1511424
    s_mov_b32 s51, 0x20000
    s_mov_b64 s[40:41], s[4:5]
    s_mov_b32 s42, 10240
    s_mov_b32 s43, 0x20000
    buffer_load_dwordx4 v[32:35], v3, s[40:43], s66 offen offset:0
    buffer_load_dword v36, v5, s[40:43], s66 offen offset:1024
    buffer_load_dwordx4 v[64:67], v3, s[40:43], s66 offen offset:1280
    buffer_load_dword v68, v5, s[40:43], s66 offen offset:2304
    buffer_load_dwordx4 v[70:73], v3, s[40:43], s66 offen offset:2560
    buffer_load_dword v74, v5, s[40:43], s66 offen offset:3584
    s_barrier
    s_mul_i32 s67, s65, 3
    s_mul_i32 s68, s67, 1296
    v_add_u32 v12, s68, v3
    v_add_u32 v13, s68, v5
    s_add_u32 s68, s67, 3
    s_min_u32 s68, s68, 8
    s_waitcnt vmcnt(0)
L_lnrow:
    v_lshlrev_b32 v40, 16, v32
    v_and_b32 v41, 0xffff0000, v32
    v_lshlrev_b32 v42, 16, v33
    v_and_b32 v43, 0xffff0000, v33
    v_lshlrev_b32 v44, 16, v34
    v_and_b32 v45, 0xffff0000, v34
    v_lshlrev_b32 v46, 16, v35
    v_and_b32 v47, 0xffff0000, v35
    v_lshlrev_b32 v48, 16, v36
    v_and_b32 v49, 0xffff0000, v36
    v_add_f32 v60, v40, v41
    v_add_f32 v61, v42, v43
    v_add_f32 v62, v44, v45
    v_add_f32 v63, v46, v47
    v_add_f32 v60, v60, v61
    v_add_f32 v62, v62, v63
    v_add_f32 v61, v48, v49
    v_add_f32 v60, v60, v62
    v_add_f32 v60, v60, v61
    s_nop 1
    v_add_f32_dpp v60, v60, v60 quad_perm:[1,0,3,2] row_mask:0xf bank_mask:0xf
    s_nop 1
    v_add_f32_dpp v60, v60, v60 quad_perm:[2,3,0,1] row_mask:0xf bank_mask:0xf
    s_nop 1
    v_add_f32_dpp v60, v60, v60 row_half_mirror row_mask:0xf bank_mask:0xf
    s_nop 1
    v_add_f32_dpp v60, v60, v60 row_ror:8 row_mask:0xf bank_mask:0xf
    v_mov_b32 v61, v60
    s_nop 1
    v_permlane16_swap_b32 v60, v61
    v_add_f32 v60, v60, v61
    v_mov_b32 v61, v60
    s_nop 1
    v_permlane32_swap_b32 v60, v61
    v_add_f32 v60, v60, v61
    v_mul_f32 v63, 0x3acccccd, v60
    v_cvt_pk_bf16_f32 v60, 0, v63
    v_sub_f32 v50, v40, v60
    v_sub_f32 v51, v41, v60
    v_sub_f32 v52, v42, v60
    v_sub_f32 v53, v43, v60
    v_sub_f32 v54, v44, v60
    v_sub_f32 v55, v45, v60
    v_sub_f32 v56, v46, v60
    v_sub_f32 v57, v47, v60
    v_sub_f32 v58, v48, v60
    v_sub_f32 v59, v49, v60
    v_mul_f32 v61, v50, v50
    v_mul_f32 v62, v51, v51
    v_fmac_f32 v61, v52, v52
    v_fmac_f32 v62, v53, v53
    v_fmac_f32 v61, v54, v54
    v_fmac_f32 v62, v55, v55
    v_fmac_f32 v61, v56, v56
    v_fmac_f32 v62, v57, v57
    v_fmac_f32 v61, v58, v58
    v_fmac_f32 v62, v59, v59
    v_add_f32 v61, v61, v62
    v_sub_f32 v63, v63, v60
    v_mul_f32 v63, v63, v63
    v_add_f32_dpp v61, v61, v61 quad_perm:[1,0,3,2] row_mask:0xf bank_mask:0xf
    v_cvt_pk_bf16_f32 v50, 0, v50
    v_cvt_pk_bf16_f32 v51, 0, v51
    v_add_f32_dpp v61, v61, v61 quad_perm:[2,3,0,1] row_mask:0xf bank_mask:0xf
    v_cvt_pk_bf16_f32 v52, 0, v52
    v_cvt_pk_bf16_f32 v53, 0, v53
    v_add_f32_dpp v61, v61, v61 row_half_mirror row_mask:0xf bank_mask:0xf
    v_cvt_pk_bf16_f32 v54, 0, v54
    v_cvt_pk_bf16_f32 v55, 0, v55
    v_add_f32_dpp v61, v61, v61 row_ror:8 row_mask:0xf bank_mask:0xf
    v_mov_b32 v62, v61
    v_cvt_pk_bf16_f32 v56, 0, v56
    v_cvt_pk_bf16_f32 v57, 0, v57
    v_permlane16_swap_b32 v61, v62
    v_add_f32 v61, v61, v62
    v_mov_b32 v62, v61
    v_cvt_pk_bf16_f32 v58, 0, v58
    v_cvt_pk_bf16_f32 v59, 0, v59
    v_permlane32_swap_b32 v61, v62
    v_add_f32 v61, v61, v62
    v_mul_f32 v61, 0x3acccccd, v61
    v_sub_f32 v61, v61, v63
    v_max_f32 v61, 0, v61
    v_cvt_pk_bf16_f32 v61, 0, v61
    v_add_f32 v61, 0x3727c5ac, v61
    v_cvt_pk_bf16_f32 v61, 0, v61
    v_sqrt_f32 v61, v61
    s_nop 0
    v_cvt_pk_bf16_f32 v61, 0, v61
    v_rcp_f32 v61, v61
    s_nop 0
    v_mul_f32 v50, v50, v61
    v_mul_f32 v51, v51, v61
    v_mul_f32 v52, v52, v61
    v_mul_f32 v53, v53, v61
    v_mul_f32 v54, v54, v61
    v_mul_f32 v55, v55, v61
    v_mul_f32 v56, v56, v61
    v_mul_f32 v57, v57, v61
    v_mul_f32 v58, v58, v61
    v_mul_f32 v59, v59, v61
    v_cvt_pk_bf16_f32 v32, v50, v51
    v_cvt_pk_bf16_f32 v33, v52, v53
    v_cvt_pk_bf16_f32 v34, v54, v55
    v_cvt_pk_bf16_f32 v35, v56, v57
    v_cvt_pk_bf16_f32 v36, v58, v59
    ds_write_b128 v12, v[32:35] offset:0
    ds_write_b32 v13, v36 offset:1024
    v_add_u32 v12, 1296, v12
    v_add_u32 v13, 1296, v13
    s_waitcnt lgkmcnt(0)
    v_mov_b32 v32, v64
    v_mov_b32 v33, v65
    v_mov_b32 v34, v66
    v_mov_b32 v35, v67
    v_mov_b32 v36, v68
    v_mov_b32 v64, v70
    v_mov_b32 v65, v71
    v_mov_b32 v66, v72
    v_mov_b32 v67, v73
    v_mov_b32 v68, v74
    s_add_u32 s67, s67, 1
    s_cmp_lt_u32 s67, s68
    s_cbranch_scc1 L_lnrow
L_rowsdone:
    v_mov_b32 v4, 0
    v_mov_b32 v7, 1
    s_mov_b64 exec, 1
    ds_add_u32 v4, v7 offset:10792
    s_mov_b64 exec, -1
    s_branch L_h123
L_h0c:
    s_mov_b64 s[52:53], s[22:23]
    s_mov_b32 s54, 256
    s_mov_b32 s55, 0x20000
    v_mov_b32 v13, 0
    s_mov_b32 s85, 1600000
L_rowsc:
    ds_read_b32 v14, v13 offset:10792
    s_sub_u32 s85, s85, 1
    s_waitcnt lgkmcnt(0)
    s_cbranch_scc1 L_rowsc_x
    v_cmp_gt_u32 vcc, 3, v14
    s_cbranch_vccnz L_rowsc
L_rowsc_x:
    s_lshl_b32 s64, s26, 5
    v_mov_b32 v7, 1
    s_mov_b64 exec, 1
    buffer_atomic_add v7, v3, s[52:55], s64 offen sc1
    s_waitcnt vmcnt(0)
    s_mov_b64 exec, 0xff
    v_lshlrev_b32 v13, 5, v0
    s_mov_b32 s85, 100000
    s_branch L_qwait
L_h0q:
    s_mov_b64 s[48:49], s[24:25]
    s_mov_b32 s50, 1511424
    s_mov_b32 s51, 0x20000
    s_mov_b64 s[40:41], s[4:5]
    s_mov_b32 s42, 10240
    s_mov_b32 s43, 0x20000
    s_mov_b64 s[52:53], s[22:23]
    s_mov_b32 s54, 256
    s_mov_b32 s55, 0x20000
    v_and_b32 v8, 7, v0
    v_mul_u32_u24 v8, 1296, v8
    v_lshl_add_u32 v8, v2, 4, v8
    s_mul_i32 s65, s63, 640
    v_add_u32 v8, s65, v8
    s_waitcnt vmcnt(32)
    v_perm_b32 v224, v68, v64, s80
    v_perm_b32 v225, v76, v72, s80
    v_perm_b32 v226, v84, v80, s80
    v_perm_b32 v227, v92, v88, s80
    v_perm_b32 v228, v68, v64, s81
    v_perm_b32 v229, v76, v72, s81
    v_perm_b32 v230, v84, v80, s81
    v_perm_b32 v231, v92, v88, s81
    v_perm_b32 v232, v69, v65, s80
    v_perm_b32 v233, v77, v73, s80
    v_perm_b32 v234, v85, v81, s80
    v_perm_b32 v235, v93, v89, s80
    v_perm_b32 v236, v69, v65, s81
    v_perm_b32 v237, v77, v73, s81
    v_perm_b32 v238, v85, v81, s81
    v_perm_b32 v239, v93, v89, s81
    v_perm_b32 v240, v70, v66, s80
    v_perm_b32 v241, v78, v74, s80
    v_perm_b32 v242, v86, v82, s80
    v_perm_b32 v243, v94, v90, s80
    v_perm_b32 v244, v70, v66, s81
    v_perm_b32 v245, v78, v74, s81
    v_perm_b32 v246, v86, v82, s81
    v_perm_b32 v247, v94, v90, s81
    v_perm_b32 v248, v71, v67, s80
    v_perm_b32 v249, v79, v75, s80
    v_perm_b32 v250, v87, v83, s80
    v_perm_b32 v251, v95, v91, s80
    v_perm_b32 v252, v71, v67, s81
    v_perm_b32 v253, v79, v75, s81
    v_perm_b32 v254, v87, v83, s81
    v_perm_b32 v255, v95, v91, s81
    s_waitcnt vmcnt(24)
    v_perm_b32 v64, v100, v96, s80
    v_perm_b32 v65, v108, v104, s80
    v_perm_b32 v66, v116, v112, s80
    v_perm_b32 v67, v124, v120, s80
    v_perm_b32 v68, v100, v96, s81
    v_perm_b32 v69, v108, v104, s81
    v_perm_b32 v70, v116, v112, s81
    v_perm_b32 v71, v124, v120, s81
    v_perm_b32 v72, v101, v97, s80
    v_perm_b32 v73, v109, v105, s80
    v_perm_b32 v74, v117, v113, s80
    v_perm_b32 v75, v125, v121, s80
    v_perm_b32 v76, v101, v97, s81
    v_perm_b32 v77, v109, v105, s81
    v_perm_b32 v78, v117, v113, s81
    v_perm_b32 v79, v125, v121, s81
    v_perm_b32 v80, v102, v98, s80
    v_perm_b32 v81, v110, v106, s80
    v_perm_b32 v82, v118, v114, s80
    v_perm_b32 v83, v126, v122, s80
    v_perm_b32 v84, v102, v98, s81
    v_perm_b32 v85, v110, v106, s81
    v_perm_b32 v86, v118, v114, s81
    v_perm_b32 v87, v126, v122, s81
    v_perm_b32 v88, v103, v99, s80
    v_perm_b32 v89, v111, v107, s80
    v_perm_b32 v90, v119, v115, s80
    v_perm_b32 v91, v127, v123, s80
    v_perm_b32 v92, v103, v99, s81
    v_perm_b32 v93, v111, v107, s81
    v_perm_b32 v94, v119, v115, s81
    v_perm_b32 v95, v127, v123, s81
    s_waitcnt vmcnt(16)
    v_perm_b32 v96, v132, v128, s80
    v_perm_b32 v97, v140, v136, s80
    v_perm_b32 v98, v148, v144, s80
    v_perm_b32 v99, v156, v152, s80
    v_perm_b32 v100, v132, v128, s81
    v_perm_b32 v101, v140, v136, s81
    v_perm_b32 v102, v148, v144, s81
    v_perm_b32 v103, v156, v152, s81
    v_perm_b32 v104, v133, v129, s80
    v_perm_b32 v105, v141, v137, s80
    v_perm_b32 v106, v149, v145, s80
    v_perm_b32 v107, v157, v153, s80
    v_perm_b32 v108, v133, v129, s81
    v_perm_b32 v109, v141, v137, s81
    v_perm_b32 v110, v149, v145, s81
    v_perm_b32 v111, v157, v153, s81
    v_perm_b32 v112, v134, v130, s80
    v_perm_b32 v113, v142, v138, s80
    v_perm_b32 v114, v150, v146, s80
    v_perm_b32 v115, v158, v154, s80
    v_perm_b32 v116, v134, v130, s81
    v_perm_b32 v117, v142, v138, s81
    v_perm_b32 v118, v150, v146, s81
    v_perm_b32 v119, v158, v154, s81
    v_perm_b32 v120, v135, v131, s80
    v_perm_b32 v121, v143, v139, s80
    v_perm_b32 v122, v151, v147, s80
    v_perm_b32 v123, v159, v155, s80
    v_perm_b32 v124, v135, v131, s81
    v_perm_b32 v125, v143, v139, s81
    v_perm_b32 v126, v151, v147, s81
    v_perm_b32 v127, v159, v155, s81
    s_waitcnt vmcnt(8)
    v_perm_b32 v128, v164, v160, s80
    v_perm_b32 v129, v172, v168, s80
    v_perm_b32 v130, v180, v176, s80
    v_perm_b32 v131, v188, v184, s80
    v_perm_b32 v132, v164, v160, s81
    v_perm_b32 v133, v172, v168, s81
    v_perm_b32 v134, v180, v176, s81
    v_perm_b32 v135, v188, v184, s81
    v_perm_b32 v136, v165, v161, s80
    v_perm_b32 v137, v173, v169, s80
    v_perm_b32 v138, v181, v177, s80
    v_perm_b32 v139, v189, v185, s80
    v_perm_b32 v140, v165, v161, s81
    v_perm_b32 v141, v173, v169, s81
    v_perm_b32 v142, v181, v177, s81
    v_perm_b32 v143, v189, v185, s81
    v_perm_b32 v144, v166, v162, s80
    v_perm_b32 v145, v174, v170, s80
    v_perm_b32 v146, v182, v178, s80
    v_perm_b32 v147, v190, v186, s80
    v_perm_b32 v148, v166, v162, s81
    v_perm_b32 v149, v174, v170, s81
    v_perm_b32 v150, v182, v178, s81
    v_perm_b32 v151, v190, v186, s81
    v_perm_b32 v152, v167, v163, s80
    v_perm_b32 v153, v175, v171, s80
    v_perm_b32 v154, v183, v179, s80
    v_perm_b32 v155, v191, v187, s80
    v_perm_b32 v156, v167, v163, s81
    v_perm_b32 v157, v175, v171, s81
    v_perm_b32 v158, v183, v179, s81
    v_perm_b32 v159, v191, v187, s81
    s_waitcnt vmcnt(0)
    v_perm_b32 v160, v196, v192, s80
    v_perm_b32 v161, v204, v200, s80
    v_perm_b32 v162, v212, v208, s80
    v_perm_b32 v163, v220, v216, s80
    v_perm_b32 v164, v196, v192, s81
    v_perm_b32 v165, v204, v200, s81
    v_perm_b32 v166, v212, v208, s81
    v_perm_b32 v167, v220, v216, s81
    v_perm_b32 v168, v197, v193, s80
    v_perm_b32 v169, v205, v201, s80
    v_perm_b32 v170, v213, v209, s80
    v_perm_b32 v171, v221, v217, s80
    v_perm_b32 v172, v197, v193, s81
    v_perm_b32 v173, v205, v201, s81
    v_perm_b32 v174, v213, v209, s81
    v_perm_b32 v175, v221, v217, s81
    v_perm_b32 v176, v198, v194, s80
    v_perm_b32 v177, v206, v202, s80
    v_perm_b32 v178, v214, v210, s80
    v_perm_b32 v179, v222, v218, s80
    v_perm_b32 v180, v198, v194, s81
    v_perm_b32 v181, v206, v202, s81
    v_perm_b32 v182, v214, v210, s81
    v_perm_b32 v183, v222, v218, s81
    v_perm_b32 v184, v199, v195, s80
    v_perm_b32 v185, v207, v203, s80
    v_perm_b32 v186, v215, v211, s80
    v_perm_b32 v187, v223, v219, s80
    v_perm_b32 v188, v199, v195, s81
    v_perm_b32 v189, v207, v203, s81
    v_perm_b32 v190, v215, v211, s81
    v_perm_b32 v191, v223, v219, s81
    v_mov_b32 v13, 0
    s_mov_b32 s85, 1600000
L_rows:
    ds_read_b32 v14, v13 offset:10792
    s_sub_u32 s85, s85, 1
    s_waitcnt lgkmcnt(0)
    s_cbranch_scc1 L_rows_x
    v_cmp_gt_u32 vcc, 3, v14
    s_cbranch_vccnz L_rows
L_rows_x:
    ds_read_b128 v[12:15], v8 offset:0
    ds_read_b128 v[16:19], v8 offset:128
    ds_read_b128 v[20:23], v8 offset:256
    ds_read_b128 v[24:27], v8 offset:384
    ds_read_b128 v[28:31], v8 offset:512
    s_waitcnt lgkmcnt(4)
    v_mfma_f32_16x16x32_bf16 v[32:35], v[12:15], v[224:227], 0
    v_mfma_f32_16x16x32_bf16 v[36:39], v[12:15], v[228:231], 0
    v_mfma_f32_16x16x32_bf16 v[40:43], v[12:15], v[232:235], 0
    v_mfma_f32_16x16x32_bf16 v[44:47], v[12:15], v[236:239], 0
    v_mfma_f32_16x16x32_bf16 v[48:51], v[12:15], v[240:243], 0
    v_mfma_f32_16x16x32_bf16 v[52:55], v[12:15], v[244:247], 0
    v_mfma_f32_16x16x32_bf16 v[56:59], v[12:15], v[248:251], 0
    v_mfma_f32_16x16x32_bf16 v[60:63], v[12:15], v[252:255], 0
    s_waitcnt lgkmcnt(3)
    v_mfma_f32_16x16x32_bf16 v[32:35], v[16:19], v[64:67], v[32:35]
    v_mfma_f32_16x16x32_bf16 v[36:39], v[16:19], v[68:71], v[36:39]
    v_mfma_f32_16x16x32_bf16 v[40:43], v[16:19], v[72:75], v[40:43]
    v_mfma_f32_16x16x32_bf16 v[44:47], v[16:19], v[76:79], v[44:47]
    v_mfma_f32_16x16x32_bf16 v[48:51], v[16:19], v[80:83], v[48:51]
    v_mfma_f32_16x16x32_bf16 v[52:55], v[16:19], v[84:87], v[52:55]
    v_mfma_f32_16x16x32_bf16 v[56:59], v[16:19], v[88:91], v[56:59]
    v_mfma_f32_16x16x32_bf16 v[60:63], v[16:19], v[92:95], v[60:63]
    s_waitcnt lgkmcnt(2)
    v_mfma_f32_16x16x32_bf16 v[32:35], v[20:23], v[96:99], v[32:35]
    v_mfma_f32_16x16x32_bf16 v[36:39], v[20:23], v[100:103], v[36:39]
    v_mfma_f32_16x16x32_bf16 v[40:43], v[20:23], v[104:107], v[40:43]
    v_mfma_f32_16x16x32_bf16 v[44:47], v[20:23], v[108:111], v[44:47]
    v_mfma_f32_16x16x32_bf16 v[48:51], v[20:23], v[112:115], v[48:51]
    v_mfma_f32_16x16x32_bf16 v[52:55], v[20:23], v[116:119], v[52:55]
    v_mfma_f32_16x16x32_bf16 v[56:59], v[20:23], v[120:123], v[56:59]
    v_mfma_f32_16x16x32_bf16 v[60:63], v[20:23], v[124:127], v[60:63]
    s_waitcnt lgkmcnt(1)
    v_mfma_f32_16x16x32_bf16 v[32:35], v[24:27], v[128:131], v[32:35]
    v_mfma_f32_16x16x32_bf16 v[36:39], v[24:27], v[132:135], v[36:39]
    v_mfma_f32_16x16x32_bf16 v[40:43], v[24:27], v[136:139], v[40:43]
    v_mfma_f32_16x16x32_bf16 v[44:47], v[24:27], v[140:143], v[44:47]
    v_mfma_f32_16x16x32_bf16 v[48:51], v[24:27], v[144:147], v[48:51]
    v_mfma_f32_16x16x32_bf16 v[52:55], v[24:27], v[148:151], v[52:55]
    v_mfma_f32_16x16x32_bf16 v[56:59], v[24:27], v[152:155], v[56:59]
    v_mfma_f32_16x16x32_bf16 v[60:63], v[24:27], v[156:159], v[60:63]
    s_waitcnt lgkmcnt(0)
    v_mfma_f32_16x16x32_bf16 v[32:35], v[28:31], v[160:163], v[32:35]
    v_mfma_f32_16x16x32_bf16 v[36:39], v[28:31], v[164:167], v[36:39]
    v_mfma_f32_16x16x32_bf16 v[40:43], v[28:31], v[168:171], v[40:43]
    v_mfma_f32_16x16x32_bf16 v[44:47], v[28:31], v[172:175], v[44:47]
    v_mfma_f32_16x16x32_bf16 v[48:51], v[28:31], v[176:179], v[48:51]
    v_mfma_f32_16x16x32_bf16 v[52:55], v[28:31], v[180:183], v[52:55]
    v_mfma_f32_16x16x32_bf16 v[56:59], v[28:31], v[184:187], v[56:59]
    v_mfma_f32_16x16x32_bf16 v[60:63], v[28:31], v[188:191], v[60:63]
    s_nop 0
    v_permlane32_swap_b32 v32, v34
    v_permlane32_swap_b32 v33, v35
    v_permlane32_swap_b32 v36, v38
    v_permlane32_swap_b32 v37, v39
    v_permlane32_swap_b32 v40, v42
    v_permlane32_swap_b32 v41, v43
    v_permlane32_swap_b32 v44, v46
    v_permlane32_swap_b32 v45, v47
    v_permlane32_swap_b32 v48, v50
    v_permlane32_swap_b32 v49, v51
    v_permlane32_swap_b32 v52, v54
    v_permlane32_swap_b32 v53, v55
    v_permlane32_swap_b32 v56, v58
    v_permlane32_swap_b32 v57, v59
    v_permlane32_swap_b32 v60, v62
    v_permlane32_swap_b32 v61, v63
    v_add_f32_dpp v64, v34, v32 row_ror:8 row_mask:0xf bank_mask:0x3
    v_add_f32_dpp v65, v38, v36 row_ror:8 row_mask:0xf bank_mask:0x3
    v_add_f32_dpp v66, v42, v40 row_ror:8 row_mask:0xf bank_mask:0x3
    v_add_f32_dpp v67, v46, v44 row_ror:8 row_mask:0xf bank_mask:0x3
    v_add_f32_dpp v68, v50, v48 row_ror:8 row_mask:0xf bank_mask:0x3
    v_add_f32_dpp v69, v54, v52 row_ror:8 row_mask:0xf bank_mask:0x3
    v_add_f32_dpp v70, v58, v56 row_ror:8 row_mask:0xf bank_mask:0x3
    v_add_f32_dpp v71, v62, v60 row_ror:8 row_mask:0xf bank_mask:0x3
    v_add_f32_dpp v64, v33, v35 row_ror:8 row_mask:0xf bank_mask:0xc
    v_add_f32_dpp v65, v37, v39 row_ror:8 row_mask:0xf bank_mask:0xc
    v_add_f32_dpp v66, v41, v43 row_ror:8 row_mask:0xf bank_mask:0xc
    v_add_f32_dpp v67, v45, v47 row_ror:8 row_mask:0xf bank_mask:0xc
    v_add_f32_dpp v68, v49, v51 row_ror:8 row_mask:0xf bank_mask:0xc
    v_add_f32_dpp v69, v53, v55 row_ror:8 row_mask:0xf bank_mask:0xc
    v_add_f32_dpp v70, v57, v59 row_ror:8 row_mask:0xf bank_mask:0xc
    v_add_f32_dpp v71, v61, v63 row_ror:8 row_mask:0xf bank_mask:0xc
    v_lshlrev_b32 v13, 5, v0
    s_mov_b64 exec, 0xff
    s_mov_b32 s85, 100000
    buffer_load_dword v14, v13, s[52:55], 0 offen
    s_branch L_qwait_c
L_qwait:
    buffer_load_dword v14, v13, s[52:55], 0 offen sc1
L_qwait_c:
    s_sub_u32 s85, s85, 1
    s_waitcnt vmcnt(0)
    s_cbranch_scc1 L_qwait_x
    v_cmp_gt_u32 vcc, 8, v14
    s_cbranch_vccnz L_qwait
L_qwait_x:
    s_mov_b64 exec, -1
    s_getreg_b32 s69, hwreg(HW_REG_XCC_ID, 0, 4)
    s_lshl_b32 s68, s26, 7
    s_add_u32 s68, s68, 1117184
    s_lshl2_add_u32 s66, s27, s68
    v_mov_b32 v12, s69
    s_mul_i32 s65, s26, 24
    s_add_u32 s67, s65, s27
    s_lshl_b32 s67, s67, 11
    s_add_u32 s67, s67, 1118208
    s_cmp_lt_u32 s27, 24
    s_cselect_b64 s[74:75], -1, 0
    s_mov_b64 exec, s[74:75]
    s_cbranch_execz L_qp0
    buffer_store_dwordx4 v[64:67], v3, s[48:51], s67 offen offset:0
    buffer_store_dwordx4 v[68:71], v3, s[48:51], s67 offen offset:1024
L_qp0:
    s_mov_b64 exec, 1
    buffer_store_dword v12, v3, s[48:51], s66 offen
    s_mov_b64 exec, -1
    v_lshl_add_u32 v8, v6, 10, v1
    s_and_b32 s70, s27, 3
    s_mul_i32 s70, s70, 3
    s_add_u32 s70, s70, s65
    s_lshl_b32 s70, s70, 11
    s_and_b32 s71, s29, 1
    s_and_b32 s72, s29, 2
    s_lshl1_add_u32 s71, s72, s71
    s_lshr_b32 s72, s29, 1
    s_and_b32 s72, s72, 2
    s_add_u32 s71, s71, s72
    s_lshl_b32 s71, s71, 7
    s_add_u32 s70, s70, s71
    s_add_u32 s71, s70, 1142784
    s_add_u32 s70, s70, 1118208
    v_lshrrev_b32 v9, 4, v0
    v_lshl_add_u32 v9, v9, 7, v1
    v_and_b32 v10, 8, v0
    v_add_u32 v9, v9, v10
    s_mov_b32 s85, 12
    s_mov_b32 s73, 0
L_pq:
    s_mov_b32 exec_hi, 0xffff
    buffer_load_dwordx4 v[16:19], v8, s[48:51], s70 offen sc1
    buffer_load_dwordx4 v[20:23], v8, s[48:51], s71 offen sc1
    buffer_load_dwordx4 v[24:27], v1, s[48:51], s68 offen sc1
    s_sub_u32 s85, s85, 1
    s_waitcnt vmcnt(0)
    s_cbranch_scc1 L_pq_late
    v_max3_u32 v4, v16, v17, v18
    v_max3_u32 v4, v4, v19, v20
    v_max3_u32 v4, v4, v21, v22
    v_max3_u32 v4, v4, v23, v24
    v_max3_u32 v4, v4, v25, v26
    v_max_u32 v4, v4, v27
    v_cmp_eq_u32 vcc, -1, v4
    s_cbranch_vccnz L_pq
L_pq_x:
    v_add_f32 v16, v16, v20
    v_add_f32 v17, v17, v21
    v_add_f32 v18, v18, v22
    v_add_f32 v19, v19, v23
    v_xor_b32 v24, s69, v24
    v_xor_b32 v25, s69, v25
    v_xor_b32 v26, s69, v26
    v_xor_b32 v27, s69, v27
    v_cvt_pk_bf16_f32 v16, v16, v17
    v_cvt_pk_bf16_f32 v17, v18, v19
    ds_write_b64 v9, v[16:17] offset:10368
    v_or3_b32 v24, v24, v25, v26
    v_or_b32 v24, v24, v27
    v_cmp_ne_u32 vcc, 0, v24
    s_mov_b64 exec, -1
    s_cmp_eq_u64 vcc, 0
    s_cselect_b32 s82, 1, 0
    v_mov_b32 v10, s82
    v_mov_b32 v11, 0
    ds_write_b32 v11, v10 offset:10784
    s_or_b32 s73, s73, s82
    s_cbranch_scc0 L_pq_far
L_pq_done:
    s_waitcnt lgkmcnt(0)
    s_setprio 0
    s_barrier
    s_lshl_b32 s72, s26, 7
    s_add_u32 s72, s72, 1107968
    s_lshl_b32 s73, s27, 2
    v_mov_b32 v11, 0
    v_mov_b32 v10, s73
    v_lshlrev_b32 v9, 2, v0
    s_mov_b64 exec, 1
    buffer_store_dword v11, v10, s[48:51], s72 offen
    s_mov_b32 exec_lo, -1
    buffer_load_dword v10, v9, s[48:51], s72 offen sc1
    s_waitcnt vmcnt(0)
    v_cmp_eq_u32 vcc, 0, v10
    s_mov_b64 exec, -1
    s_bcnt1_i32_b32 s73, vcc_lo
    v_mov_b32 v10, s73
    ds_write_b32 v11, v10 offset:10816
    v_mov_b32 v13, 0
    s_mov_b32 s85, 1600000
L_kprog00:
    s_sleep 4
    ds_read_b32 v14, v13 offset:10796
    s_sub_u32 s85, s85, 1
    s_waitcnt lgkmcnt(0)
    s_cbranch_scc1 L_kprog00_x
    v_cmp_gt_u32 vcc, 1, v14
    s_cbranch_vccnz L_kprog00
L_kprog00_x:
    s_lshl_b32 s72, s26, 7
    s_add_u32 s72, s72, 1110016
    s_lshl_b32 s73, s27, 2
    v_mov_b32 v11, 0
    v_mov_b32 v10, s73
    v_lshlrev_b32 v9, 2, v0
    s_mov_b64 exec, 1
    buffer_store_dword v11, v10, s[48:51], s72 offen
    s_mov_b32 exec_lo, -1
    buffer_load_dword v10, v9, s[48:51], s72 offen sc1
    s_waitcnt vmcnt(0)
    v_cmp_eq_u32 vcc, 0, v10
    s_mov_b64 exec, -1
    s_bcnt1_i32_b32 s73, vcc_lo
    v_mov_b32 v10, s73
    ds_write_b32 v11, v10 offset:10824
    s_barrier
    s_lshl_b32 s60, s30, 10
    s_add_u32 s60, s60, 40672
    v_add_u32 v4, s60, v3
    v_add_u32 v5, 0x10000, v4
    ds_read_b128 v[176:179], v4 offset:0
    ds_read_b128 v[180:183], v4 offset:8192
    ds_read_b128 v[184:187], v4 offset:16384
    ds_read_b128 v[188:191], v4 offset:24576
    ds_read_b128 v[192:195], v4 offset:32768
    ds_read_b128 v[196:199], v4 offset:40960
    ds_read_b128 v[200:203], v4 offset:49152
    ds_read_b128 v[204:207], v4 offset:57344
    ds_read_b128 v[208:211], v5 offset:0
    ds_read_b128 v[212:215], v5 offset:8192
    s_lshl_b32 s72, s26, 7
    s_add_u32 s72, s72, 1108992
    s_lshl_b32 s73, s27, 2
    v_mov_b32 v11, 0
    v_mov_b32 v10, s73
    v_lshlrev_b32 v9, 2, v0
    s_mov_b64 exec, 1
    buffer_store_dword v11, v10, s[48:51], s72 offen
    s_mov_b32 exec_lo, -1
    buffer_load_dword v10, v9, s[48:51], s72 offen sc1
    s_waitcnt vmcnt(0)
    v_cmp_eq_u32 vcc, 0, v10
    s_mov_b64 exec, -1
    s_bcnt1_i32_b32 s73, vcc_lo
    v_mov_b32 v10, s73
    ds_write_b32 v11, v10 offset:10820
    s_waitcnt lgkmcnt(0)
    s_barrier
    v_mov_b32 v13, 0
    s_mov_b32 s85, 1600000
L_vprog00:
    s_sleep 4
    ds_read_b32 v14, v13 offset:10796
    s_sub_u32 s85, s85, 1
    s_waitcnt lgkmcnt(0)
    s_cbranch_scc1 L_vprog00_x
    v_cmp_gt_u32 vcc, 2, v14
    s_cbranch_vccnz L_vprog00
L_vprog00_x:
    s_lshl_b32 s72, s26, 7
    s_add_u32 s72, s72, 1111040
    s_lshl_b32 s73, s27, 2
    v_mov_b32 v11, 0
    v_mov_b32 v10, s73
    v_lshlrev_b32 v9, 2, v0
    s_mov_b64 exec, 1
    buffer_store_dword v11, v10, s[48:51], s72 offen
    s_mov_b32 exec_lo, -1
    buffer_load_dword v10, v9, s[48:51], s72 offen sc1
    s_waitcnt vmcnt(0)
    v_cmp_eq_u32 vcc, 0, v10
    s_mov_b64 exec, -1
    s_bcnt1_i32_b32 s73, vcc_lo
    v_mov_b32 v10, s73
    ds_write_b32 v11, v10 offset:10828
    v_mov_b32 v13, 0
    s_mov_b32 s85, 1600000
L_vprog01:
    s_sleep 4
    ds_read_b32 v14, v13 offset:10796
    s_sub_u32 s85, s85, 1
    s_waitcnt lgkmcnt(0)
    s_cbranch_scc1 L_vprog01_x
    v_cmp_gt_u32 vcc, 3, v14
    s_cbranch_vccnz L_vprog01
L_vprog01_x:
    s_lshl_b32 s72, s26, 7
    s_add_u32 s72, s72, 1112064
    s_lshl_b32 s73, s27, 2
    v_mov_b32 v11, 0
    v_mov_b32 v10, s73
    v_lshlrev_b32 v9, 2, v0
    s_mov_b64 exec, 1
    buffer_store_dword v11, v10, s[48:51], s72 offen
    s_mov_b32 exec_lo, -1
    buffer_load_dword v10, v9, s[48:51], s72 offen sc1
    s_waitcnt vmcnt(0)
    v_cmp_eq_u32 vcc, 0, v10
    s_mov_b64 exec, -1
    s_bcnt1_i32_b32 s73, vcc_lo
    v_mov_b32 v10, s73
    ds_write_b32 v11, v10 offset:10832
    v_mov_b32 v13, 0
    s_mov_b32 s85, 1600000
L_vprog02:
    s_sleep 4
    ds_read_b32 v14, v13 offset:10796
    s_sub_u32 s85, s85, 1
    s_waitcnt lgkmcnt(0)
    s_cbranch_scc1 L_vprog02_x
    v_cmp_gt_u32 vcc, 4, v14
    s_cbranch_vccnz L_vprog02
L_vprog02_x:
    s_lshl_b32 s72, s26, 7
    s_add_u32 s72, s72, 1113088
    s_lshl_b32 s73, s27, 2
    v_mov_b32 v11, 0
    v_mov_b32 v10, s73
    v_lshlrev_b32 v9, 2, v0
    s_mov_b64 exec, 1
    buffer_store_dword v11, v10, s[48:51], s72 offen
    s_mov_b32 exec_lo, -1
    buffer_load_dword v10, v9, s[48:51], s72 offen sc1
    s_waitcnt vmcnt(0)
    v_cmp_eq_u32 vcc, 0, v10
    s_mov_b64 exec, -1
    s_bcnt1_i32_b32 s73, vcc_lo
    v_mov_b32 v10, s73
    ds_write_b32 v11, v10 offset:10836
    v_mov_b32 v13, 0
    s_mov_b32 s85, 1600000
L_vprog03:
    s_sleep 4
    ds_read_b32 v14, v13 offset:10796
    s_sub_u32 s85, s85, 1
    s_waitcnt lgkmcnt(0)
    s_cbranch_scc1 L_vprog03_x
    v_cmp_gt_u32 vcc, 5, v14
    s_cbranch_vccnz L_vprog03
L_vprog03_x:
    s_lshl_b32 s72, s26, 7
    s_add_u32 s72, s72, 1114112
    s_lshl_b32 s73, s27, 2
    v_mov_b32 v11, 0
    v_mov_b32 v10, s73
    v_lshlrev_b32 v9, 2, v0
    s_mov_b64 exec, 1
    buffer_store_dword v11, v10, s[48:51], s72 offen
    s_mov_b32 exec_lo, -1
    buffer_load_dword v10, v9, s[48:51], s72 offen sc1
    s_waitcnt vmcnt(0)
    v_cmp_eq_u32 vcc, 0, v10
    s_mov_b64 exec, -1
    s_bcnt1_i32_b32 s73, vcc_lo
    v_mov_b32 v10, s73
    ds_write_b32 v11, v10 offset:10840
    s_branch L_wo
L_stream:
    s_add_u32 s36, s8, s60
    s_addc_u32 s37, s9, 0
    s_mov_b32 s38, 98304
    s_mov_b32 s39, 0x20000
    s_mov_b64 s[48:49], s[24:25]
    s_mov_b32 s50, 1511424
    s_mov_b32 s51, 0x20000
    s_mov_b64 s[40:41], s[4:5]
    s_mov_b32 s42, 10240
    s_mov_b32 s43, 0x20000
    v_and_b32 v4, 1, v0
    v_lshlrev_b32 v4, 4, v4
    v_mov_b32 v7, 0xffff
    v_lshlrev_b32 v4, v4, v7
    v_bfe_u32 v7, v0, 1, 2
    v_cmp_eq_u32 vcc, 0, v7
    s_nop 1
    v_cndmask_b32 v28, 0, v4, vcc
    v_cmp_eq_u32 vcc, 1, v7
    s_nop 1
    v_cndmask_b32 v29, 0, v4, vcc
    v_cmp_eq_u32 vcc, 2, v7
    s_nop 1
    v_cndmask_b32 v30, 0, v4, vcc
    v_cmp_eq_u32 vcc, 3, v7
    s_nop 1
    v_cndmask_b32 v31, 0, v4, vcc
    s_mov_b32 s63, 0
    s_mov_b32 s64, 1
    s_cmp_lt_u32 s27, 24
    s_cselect_b32 s63, 1, s63
    s_cselect_b32 s64, 2, s64
    s_cmp_ge_u32 s27, 8
    s_cselect_b32 s64, s64, s63
    s_cmp_eq_u32 s26, 0
    s_cselect_b32 s31, s64, s63
    s_mov_b32 s83, 0
    s_mov_b32 s3, 1
    s_mov_b64 vcc, 0
    s_barrier
    s_addk_i32 s84, 3072
    s_cmp_eq_u32 s84, s34
    s_cselect_b32 s84, 0, s84
    buffer_load_dwordx4 v[76:79], v12, s[32:35], s84 offen offset:0 nt
    s_bitcmp1_b32 s3, 0
    s_cbranch_vccnz L_hi1
    s_waitcnt vmcnt(4)
    s_cbranch_scc1 L_go1
    s_waitcnt vmcnt(3)
L_hi1:
    s_cbranch_scc1 L_go1
    s_waitcnt vmcnt(5)
L_go1:
    buffer_load_dwordx4 v[80:83], v12, s[32:35], s84 offen offset:128 nt
    s_bitcmp1_b32 s3, 0
    s_cbranch_vccnz L_hi2
    s_waitcnt vmcnt(4)
    s_cbranch_scc1 L_go2
    s_waitcnt vmcnt(3)
L_hi2:
    s_cbranch_scc1 L_go2
    s_waitcnt vmcnt(5)
L_go2:
    buffer_load_dwordx4 v[84:87], v12, s[32:35], s84 offen offset:256 nt
    s_addk_i32 s84, 3072
    s_cmp_eq_u32 s84, s34
    s_cselect_b32 s84, 0, s84
    s_sub_u32 s83, s83, 1
    s_cselect_b32 s83, 0, s83
    s_cselect_b32 s3, s31, s2
    s_bitcmp1_b32 s3, 1
    s_cselect_b64 vcc, -1, 0
    s_bitcmp1_b32 s3, 0
    s_cbranch_vccnz L_hi3
    s_waitcnt vmcnt(4)
    s_cbranch_scc1 L_go3
    s_waitcnt vmcnt(3)
L_hi3:
    s_cbranch_scc1 L_go3
    s_waitcnt vmcnt(5)
L_go3:
    buffer_load_dwordx4 v[88:91], v12, s[32:35], s84 offen offset:0 nt
    s_bitcmp1_b32 s3, 0
    s_waitcnt vmcnt(6)
    s_cbranch_vccnz L_hi4
    s_waitcnt vmcnt(4)
    s_cbranch_scc1 L_go4
    s_waitcnt vmcnt(3)
L_hi4:
    s_cbranch_scc1 L_go4
    s_waitcnt vmcnt(5)
L_go4:
    buffer_load_dwordx4 v[92:95], v12, s[32:35], s84 offen offset:128 nt
    s_bitcmp1_b32 s3, 0
    s_waitcnt vmcnt(6)
    s_cbranch_vccnz L_hi5
    s_waitcnt vmcnt(4)
    s_cbranch_scc1 L_go5
    s_waitcnt vmcnt(3)
L_hi5:
    s_cbranch_scc1 L_go5
    s_waitcnt vmcnt(5)
L_go5:
    buffer_load_dwordx4 v[96:99], v12, s[32:35], s84 offen offset:256 nt
    s_addk_i32 s84, 3072
    s_cmp_eq_u32 s84, s34
    s_cselect_b32 s84, 0, s84
    s_sub_u32 s83, s83, 1
    s_cselect_b32 s83, 0, s83
    s_cselect_b32 s3, s31, s2
    s_bitcmp1_b32 s3, 1
    s_cselect_b64 vcc, -1, 0
    s_bitcmp1_b32 s3, 0
    s_waitcnt vmcnt(6)
    s_cbranch_vccnz L_hi6
    s_waitcnt vmcnt(4)
    s_cbranch_scc1 L_go6
    s_waitcnt vmcnt(3)
L_hi6:
    s_cbranch_scc1 L_go6
    s_waitcnt vmcnt(5)
L_go6:
    buffer_load_dwordx4 v[100:103], v12, s[32:35], s84 offen offset:0 nt
    s_bitcmp1_b32 s3, 0
    s_waitcnt vmcnt(6)
    s_cbranch_vccnz L_hi7
    s_waitcnt vmcnt(4)
    s_cbranch_scc1 L_go7
    s_waitcnt vmcnt(3)
L_hi7:
    s_cbranch_scc1 L_go7
    s_waitcnt vmcnt(5)
L_go7:
    buffer_load_dwordx4 v[104:107], v12, s[32:35], s84 offen offset:128 nt
    s_bitcmp1_b32 s3, 0
    s_waitcnt vmcnt(6)
    s_cbranch_vccnz L_hi8
    s_waitcnt vmcnt(4)
    s_cbranch_scc1 L_go8
    s_waitcnt vmcnt(3)
L_hi8:
    s_cbranch_scc1 L_go8
    s_waitcnt vmcnt(5)
L_go8:
    buffer_load_dwordx4 v[108:111], v12, s[32:35], s84 offen offset:256 nt
    s_addk_i32 s84, 3072
    s_cmp_eq_u32 s84, s34
    s_cselect_b32 s84, 0, s84
    s_sub_u32 s83, s83, 1
    s_cselect_b32 s83, 0, s83
    s_cselect_b32 s3, s31, s2
    s_bitcmp1_b32 s3, 1
    s_cselect_b64 vcc, -1, 0
    s_bitcmp1_b32 s3, 0
    s_waitcnt vmcnt(6)
    s_cbranch_vccnz L_hi9
    s_waitcnt vmcnt(4)
    s_cbranch_scc1 L_go9
    s_waitcnt vmcnt(3)
L_hi9:
    s_cbranch_scc1 L_go9
    s_waitcnt vmcnt(5)
L_go9:
    buffer_load_dwordx4 v[112:115], v12, s[32:35], s84 offen offset:0 nt
    s_bitcmp1_b32 s3, 0
    s_waitcnt vmcnt(6)
    s_cbranch_vccnz L_hi10
    s_waitcnt vmcnt(4)
    s_cbranch_scc1 L_go10
    s_waitcnt vmcnt(3)
L_hi10:
    s_cbranch_scc1 L_go10
    s_waitcnt vmcnt(5)
L_go10:
    buffer_load_dwordx4 v[116:119], v12, s[32:35], s84 offen offset:128 nt
    s_bitcmp1_b32 s3, 0
    s_waitcnt vmcnt(6)
    s_cbranch_vccnz L_hi11
    s_waitcnt vmcnt(4)
    s_cbranch_scc1 L_go11
    s_waitcnt vmcnt(3)
L_hi11:
    s_cbranch_scc1 L_go11
    s_waitcnt vmcnt(5)
L_go11:
    buffer_load_dwordx4 v[120:123], v12, s[32:35], s84 offen offset:256 nt
    s_addk_i32 s84, 3072
    s_cmp_eq_u32 s84, s34
    s_cselect_b32 s84, 0, s84
    s_sub_u32 s83, s83, 1
    s_cselect_b32 s83, 0, s83
    s_cselect_b32 s3, s31, s2
    s_bitcmp1_b32 s3, 1
    s_cselect_b64 vcc, -1, 0
    s_bitcmp1_b32 s3, 0
    s_waitcnt vmcnt(6)
    s_cbranch_vccnz L_hi12
    s_waitcnt vmcnt(4)
    s_cbranch_scc1 L_go12
    s_waitcnt vmcnt(3)
L_hi12:
    s_cbranch_scc1 L_go12
    s_waitcnt vmcnt(5)
L_go12:
    buffer_load_dwordx4 v[124:127], v12, s[32:35], s84 offen offset:0 nt
    s_bitcmp1_b32 s3, 0
    s_waitcnt vmcnt(6)
    s_cbranch_vccnz L_hi13
    s_waitcnt vmcnt(4)
    s_cbranch_scc1 L_go13
    s_waitcnt vmcnt(3)
L_hi13:
    s_cbranch_scc1 L_go13
    s_waitcnt vmcnt(5)
L_go13:
    buffer_load_dwordx4 v[128:131], v12, s[32:35], s84 offen offset:128 nt
    s_bitcmp1_b32 s3, 0
    s_waitcnt vmcnt(6)
    s_cbranch_vccnz L_hi14
    s_waitcnt vmcnt(4)
    s_cbranch_scc1 L_go14
    s_waitcnt vmcnt(3)
L_hi14:
    s_cbranch_scc1 L_go14
    s_waitcnt vmcnt(5)
L_go14:
    buffer_load_dwordx4 v[132:135], v12, s[32:35], s84 offen offset:256 nt
    s_addk_i32 s84, 3072
    s_cmp_eq_u32 s84, s34
    s_cselect_b32 s84, 0, s84
    s_sub_u32 s83, s83, 1
    s_cselect_b32 s83, 0, s83
    s_cselect_b32 s3, s31, s2
    s_bitcmp1_b32 s3, 1
    s_cselect_b64 vcc, -1, 0
    s_bitcmp1_b32 s3, 0
    s_waitcnt vmcnt(6)
    s_cbranch_vccnz L_hi15
    s_waitcnt vmcnt(4)
    s_cbranch_scc1 L_go15
    s_waitcnt vmcnt(3)
L_hi15:
    s_cbranch_scc1 L_go15
    s_waitcnt vmcnt(5)
L_go15:
    buffer_load_dwordx4 v[136:139], v12, s[32:35], s84 offen offset:0 nt
    s_bitcmp1_b32 s3, 0
    s_waitcnt vmcnt(6)
    s_cbranch_vccnz L_hi16
    s_waitcnt vmcnt(4)
    s_cbranch_scc1 L_go16
    s_waitcnt vmcnt(3)
L_hi16:
    s_cbranch_scc1 L_go16
    s_waitcnt vmcnt(5)
L_go16:
    buffer_load_dwordx4 v[140:143], v12, s[32:35], s84 offen offset:128 nt
    s_bitcmp1_b32 s3, 0
    s_waitcnt vmcnt(6)
    s_cbranch_vccnz L_hi17
    s_waitcnt vmcnt(4)
    s_cbranch_scc1 L_go17
    s_waitcnt vmcnt(3)
L_hi17:
    s_cbranch_scc1 L_go17
    s_waitcnt vmcnt(5)
L_go17:
    buffer_load_dwordx4 v[144:147], v12, s[32:35], s84 offen offset:256 nt
    s_addk_i32 s84, 3072
    s_cmp_eq_u32 s84, s34
    s_cselect_b32 s84, 0, s84
    s_sub_u32 s83, s83, 1
    s_cselect_b32 s83, 0, s83
    s_cselect_b32 s3, s31, s2
    s_bitcmp1_b32 s3, 1
    s_cselect_b64 vcc, -1, 0
    s_bitcmp1_b32 s3, 0
    s_waitcnt vmcnt(6)
    s_cbranch_vccnz L_hi18
    s_waitcnt vmcnt(4)
    s_cbranch_scc1 L_go18
    s_waitcnt vmcnt(3)
L_hi18:
    s_cbranch_scc1 L_go18
    s_waitcnt vmcnt(5)
L_go18:
    buffer_load_dwordx4 v[148:151], v12, s[32:35], s84 offen offset:0 nt
    s_bitcmp1_b32 s3, 0
    s_waitcnt vmcnt(6)
    s_cbranch_vccnz L_hi19
    s_waitcnt vmcnt(4)
    s_cbranch_scc1 L_go19
    s_waitcnt vmcnt(3)
L_hi19:
    s_cbranch_scc1 L_go19
    s_waitcnt vmcnt(5)
L_go19:
    buffer_load_dwordx4 v[152:155], v12, s[32:35], s84 offen offset:128 nt
    s_bitcmp1_b32 s3, 0
    s_waitcnt vmcnt(6)
    s_cbranch_vccnz L_hi20
    s_waitcnt vmcnt(4)
    s_cbranch_scc1 L_go20
    s_waitcnt vmcnt(3)
L_hi20:
    s_cbranch_scc1 L_go20
    s_waitcnt vmcnt(5)
L_go20:
    buffer_load_dwordx4 v[156:159], v12, s[32:35], s84 offen offset:256 nt
    s_addk_i32 s84, 3072
    s_cmp_eq_u32 s84, s34
    s_cselect_b32 s84, 0, s84
    s_sub_u32 s83, s83, 1
    s_cselect_b32 s83, 0, s83
    s_cselect_b32 s3, s31, s2
    s_bitcmp1_b32 s3, 1
    s_cselect_b64 vcc, -1, 0
    s_bitcmp1_b32 s3, 0
    s_waitcnt vmcnt(6)
    s_cbranch_vccnz L_hi21
    s_waitcnt vmcnt(4)
    s_cbranch_scc1 L_go21
    s_waitcnt vmcnt(3)
L_hi21:
    s_cbranch_scc1 L_go21
    s_waitcnt vmcnt(5)
L_go21:
    buffer_load_dwordx4 v[160:163], v12, s[32:35], s84 offen offset:0 nt
    s_bitcmp1_b32 s3, 0
    s_waitcnt vmcnt(6)
    s_cbranch_vccnz L_hi22
    s_waitcnt vmcnt(4)
    s_cbranch_scc1 L_go22
    s_waitcnt vmcnt(3)
L_hi22:
    s_cbranch_scc1 L_go22
    s_waitcnt vmcnt(5)
L_go22:
    buffer_load_dwordx4 v[164:167], v12, s[32:35], s84 offen offset:128 nt
    s_bitcmp1_b32 s3, 0
    s_waitcnt vmcnt(6)
    s_cbranch_vccnz L_hi23
    s_waitcnt vmcnt(4)
    s_cbranch_scc1 L_go23
    s_waitcnt vmcnt(3)
L_hi23:
    s_cbranch_scc1 L_go23
    s_waitcnt vmcnt(5)
L_go23:
    buffer_load_dwordx4 v[168:171], v12, s[32:35], s84 offen offset:256 nt
    s_addk_i32 s84, 3072
    s_cmp_eq_u32 s84, s34
    s_cselect_b32 s84, 0, s84
    s_sub_u32 s83, s83, 1
    s_cselect_b32 s83, 0, s83
    s_cselect_b32 s3, s31, s2
    s_bitcmp1_b32 s3, 1
    s_cselect_b64 vcc, -1, 0
    s_bitcmp1_b32 s3, 0
    s_waitcnt vmcnt(6)
    s_cbranch_vccnz L_hi24
    s_waitcnt vmcnt(4)
    s_cbranch_scc1 L_go24
    s_waitcnt vmcnt(3)
L_hi24:
    s_cbranch_scc1 L_go24
    s_waitcnt vmcnt(5)
L_go24:
    buffer_load_dwordx4 v[172:175], v12, s[32:35], s84 offen offset:0 nt
    s_bitcmp1_b32 s3, 0
    s_waitcnt vmcnt(6)
    s_cbranch_vccnz L_hi25
    s_waitcnt vmcnt(4)
    s_cbranch_scc1 L_go25
    s_waitcnt vmcnt(3)
L_hi25:
    s_cbranch_scc1 L_go25
    s_waitcnt vmcnt(5)
L_go25:
    buffer_load_dwordx4 v[176:179], v12, s[32:35], s84 offen offset:128 nt
    s_bitcmp1_b32 s3, 0
    s_waitcnt vmcnt(6)
    s_cbranch_vccnz L_hi26
    s_waitcnt vmcnt(4)
    s_cbranch_scc1 L_go26
    s_waitcnt vmcnt(3)
L_hi26:
    s_cbranch_scc1 L_go26
    s_waitcnt vmcnt(5)
L_go26:
    buffer_load_dwordx4 v[180:183], v12, s[32:35], s84 offen offset:256 nt
    s_addk_i32 s84, 3072
    s_cmp_eq_u32 s84, s34
    s_cselect_b32 s84, 0, s84
    s_sub_u32 s83, s83, 1
    s_cselect_b32 s83, 0, s83
    s_cselect_b32 s3, s31, s2
    s_bitcmp1_b32 s3, 1
    s_cselect_b64 vcc, -1, 0
    s_bitcmp1_b32 s3, 0
    s_waitcnt vmcnt(6)
    s_cbranch_vccnz L_hi27
    s_waitcnt vmcnt(4)
    s_cbranch_scc1 L_go27
    s_waitcnt vmcnt(3)
L_hi27:
    s_cbranch_scc1 L_go27
    s_waitcnt vmcnt(5)
L_go27:
    buffer_load_dwordx4 v[184:187], v12, s[32:35], s84 offen offset:0 nt
    s_bitcmp1_b32 s3, 0
    s_waitcnt vmcnt(6)
    s_cbranch_vccnz L_hi28
    s_waitcnt vmcnt(4)
    s_cbranch_scc1 L_go28
    s_waitcnt vmcnt(3)
L_hi28:
    s_cbranch_scc1 L_go28
    s_waitcnt vmcnt(5)
L_go28:
    buffer_load_dwordx4 v[188:191], v12, s[32:35], s84 offen offset:128 nt
    s_bitcmp1_b32 s3, 0
    s_waitcnt vmcnt(6)
    s_cbranch_vccnz L_hi29
    s_waitcnt vmcnt(4)
    s_cbranch_scc1 L_go29
    s_waitcnt vmcnt(3)
L_hi29:
    s_cbranch_scc1 L_go29
    s_waitcnt vmcnt(5)
L_go29:
    buffer_load_dwordx4 v[192:195], v12, s[32:35], s84 offen offset:256 nt
    s_addk_i32 s84, 3072
    s_cmp_eq_u32 s84, s34
    s_cselect_b32 s84, 0, s84
    s_sub_u32 s83, s83, 1
    s_cselect_b32 s83, 0, s83
    s_cselect_b32 s3, s31, s2
    s_bitcmp1_b32 s3, 1
    s_cselect_b64 vcc, -1, 0
    s_bitcmp1_b32 s3, 0
    s_waitcnt vmcnt(6)
    s_cbranch_vccnz L_hi30
    s_waitcnt vmcnt(4)
    s_cbranch_scc1 L_go30
    s_waitcnt vmcnt(3)
L_hi30:
    s_cbranch_scc1 L_go30
    s_waitcnt vmcnt(5)
L_go30:
    buffer_load_dwordx4 v[196:199], v12, s[32:35], s84 offen offset:0 nt
    s_bitcmp1_b32 s3, 0
    s_waitcnt vmcnt(6)
    s_cbranch_vccnz L_hi31
    s_waitcnt vmcnt(4)
    s_cbranch_scc1 L_go31
    s_waitcnt vmcnt(3)
L_hi31:
    s_cbranch_scc1 L_go31
    s_waitcnt vmcnt(5)
L_go31:
    buffer_load_dwordx4 v[200:203], v12, s[32:35], s84 offen offset:128 nt
    s_bitcmp1_b32 s3, 0
    s_waitcnt vmcnt(6)
    s_cbranch_vccnz L_hi32
    s_waitcnt vmcnt(4)
    s_cbranch_scc1 L_go32
    s_waitcnt vmcnt(3)
L_hi32:
    s_cbranch_scc1 L_go32
    s_waitcnt vmcnt(5)
L_go32:
    buffer_load_dwordx4 v[204:207], v12, s[32:35], s84 offen offset:256 nt
    s_addk_i32 s84, 3072
    s_cmp_eq_u32 s84, s34
    s_cselect_b32 s84, 0, s84
    s_sub_u32 s83, s83, 1
    s_cselect_b32 s83, 0, s83
    s_cselect_b32 s3, s31, s2
    s_bitcmp1_b32 s3, 1
    s_cselect_b64 vcc, -1, 0
    s_bitcmp1_b32 s3, 0
    s_waitcnt vmcnt(6)
    s_cbranch_vccnz L_hi33
    s_waitcnt vmcnt(4)
    s_cbranch_scc1 L_go33
    s_waitcnt vmcnt(3)
L_hi33:
    s_cbranch_scc1 L_go33
    s_waitcnt vmcnt(5)
L_go33:
    buffer_load_dwordx4 v[208:211], v12, s[32:35], s84 offen offset:0 nt
    s_bitcmp1_b32 s3, 0
    s_waitcnt vmcnt(6)
    s_cbranch_vccnz L_hi34
    s_waitcnt vmcnt(4)
    s_cbranch_scc1 L_go34
    s_waitcnt vmcnt(3)
L_hi34:
    s_cbranch_scc1 L_go34
    s_waitcnt vmcnt(5)
L_go34:
    buffer_load_dwordx4 v[212:215], v12, s[32:35], s84 offen offset:128 nt
    s_bitcmp1_b32 s3, 0
    s_waitcnt vmcnt(6)
    s_cbranch_vccnz L_hi35
    s_waitcnt vmcnt(4)
    s_cbranch_scc1 L_go35
    s_waitcnt vmcnt(3)
L_hi35:
    s_cbranch_scc1 L_go35
    s_waitcnt vmcnt(5)
L_go35:
    buffer_load_dwordx4 v[216:219], v12, s[32:35], s84 offen offset:256 nt
    s_addk_i32 s84, 3072
    s_cmp_eq_u32 s84, s34
    s_cselect_b32 s84, 0, s84
    s_sub_u32 s83, s83, 1
    s_cselect_b32 s83, 0, s83
    s_cselect_b32 s3, s31, s2
    s_bitcmp1_b32 s3, 1
    s_cselect_b64 vcc, -1, 0
    s_bitcmp1_b32 s3, 0
    s_waitcnt vmcnt(6)
    s_cbranch_vccnz L_hi36
    s_waitcnt vmcnt(4)
    s_cbranch_scc1 L_go36
    s_waitcnt vmcnt(3)
L_hi36:
    s_cbranch_scc1 L_go36
    s_waitcnt vmcnt(5)
L_go36:
    buffer_load_dwordx4 v[220:223], v12, s[32:35], s84 offen offset:0 nt
    s_bitcmp1_b32 s3, 0
    s_waitcnt vmcnt(6)
    s_cbranch_vccnz L_hi37
    s_waitcnt vmcnt(4)
    s_cbranch_scc1 L_go37
    s_waitcnt vmcnt(3)
L_hi37:
    s_cbranch_scc1 L_go37
    s_waitcnt vmcnt(5)
L_go37:
    buffer_load_dwordx4 v[224:227], v12, s[32:35], s84 offen offset:128 nt
    s_bitcmp1_b32 s3, 0
    s_waitcnt vmcnt(6)
    s_cbranch_vccnz L_hi38
    s_waitcnt vmcnt(4)
    s_cbranch_scc1 L_go38
    s_waitcnt vmcnt(3)
L_hi38:
    s_cbranch_scc1 L_go38
    s_waitcnt vmcnt(5)
L_go38:
    buffer_load_dwordx4 v[228:231], v12, s[32:35], s84 offen offset:256 nt
    s_addk_i32 s84, 3072
    s_cmp_eq_u32 s84, s34
    s_cselect_b32 s84, 0, s84
    s_sub_u32 s83, s83, 1
    s_cselect_b32 s83, 0, s83
    s_cselect_b32 s3, s31, s2
    s_bitcmp1_b32 s3, 1
    s_cselect_b64 vcc, -1, 0
    s_bitcmp1_b32 s3, 0
    s_waitcnt vmcnt(6)
    s_cbranch_vccnz L_hi39
    s_waitcnt vmcnt(4)
    s_cbranch_scc1 L_go39
    s_waitcnt vmcnt(3)
L_hi39:
    s_cbranch_scc1 L_go39
    s_waitcnt vmcnt(5)
L_go39:
    buffer_load_dwordx4 v[232:235], v12, s[32:35], s84 offen offset:0 nt
    s_bitcmp1_b32 s3, 0
    s_waitcnt vmcnt(6)
    s_cbranch_vccnz L_hi40
    s_waitcnt vmcnt(4)
    s_cbranch_scc1 L_go40
    s_waitcnt vmcnt(3)
L_hi40:
    s_cbranch_scc1 L_go40
    s_waitcnt vmcnt(5)
L_go40:
    buffer_load_dwordx4 v[236:239], v12, s[32:35], s84 offen offset:128 nt
    s_bitcmp1_b32 s3, 0
    s_waitcnt vmcnt(6)
    s_cbranch_vccnz L_hi41
    s_waitcnt vmcnt(4)
    s_cbranch_scc1 L_go41
    s_waitcnt vmcnt(3)
L_hi41:
    s_cbranch_scc1 L_go41
    s_waitcnt vmcnt(5)
L_go41:
    buffer_load_dwordx4 v[240:243], v12, s[32:35], s84 offen offset:256 nt
    s_addk_i32 s84, 3072
    s_cmp_eq_u32 s84, s34
    s_cselect_b32 s84, 0, s84
    s_sub_u32 s83, s83, 1
    s_cselect_b32 s83, 0, s83
    s_cselect_b32 s3, s31, s2
    s_bitcmp1_b32 s3, 1
    s_cselect_b64 vcc, -1, 0
    s_bitcmp1_b32 s3, 0
    s_waitcnt vmcnt(6)
    s_cbranch_vccnz L_hi42
    s_waitcnt vmcnt(4)
    s_cbranch_scc1 L_go42
    s_waitcnt vmcnt(3)
L_hi42:
    s_cbranch_scc1 L_go42
    s_waitcnt vmcnt(5)
L_go42:
    buffer_load_dwordx4 v[244:247], v12, s[32:35], s84 offen offset:0 nt
    s_bitcmp1_b32 s3, 0
    s_waitcnt vmcnt(6)
    s_cbranch_vccnz L_hi43
    s_waitcnt vmcnt(4)
    s_cbranch_scc1 L_go43
    s_waitcnt vmcnt(3)
L_hi43:
    s_cbranch_scc1 L_go43
    s_waitcnt vmcnt(5)
L_go43:
    buffer_load_dwordx4 v[248:251], v12, s[32:35], s84 offen offset:128 nt
    s_bitcmp1_b32 s3, 0
    s_waitcnt vmcnt(6)
    s_cbranch_vccnz L_hi44
    s_waitcnt vmcnt(4)
    s_cbranch_scc1 L_go44
    s_waitcnt vmcnt(3)
L_hi44:
    s_cbranch_scc1 L_go44
    s_waitcnt vmcnt(5)
L_go44:
    buffer_load_dwordx4 v[252:255], v12, s[32:35], s84 offen offset:256 nt
    s_barrier
    ds_read_b128 v[16:19], v1 offset:10368
    ds_read_b128 v[20:23], v1 offset:10496
    ds_read_b128 v[24:27], v1 offset:10624
    s_mov_b32 s63, 1
    s_mov_b32 s64, 2
    s_cmp_lt_u32 s27, 24
    s_cselect_b32 s63, 1, s63
    s_cselect_b32 s64, 2, s64
    s_cmp_ge_u32 s27, 8
    s_cselect_b32 s64, s64, s63
    s_cmp_eq_u32 s26, 0
    s_cselect_b32 s31, s64, s63
    s_waitcnt lgkmcnt(0)
    v_dot2_f32_bf16 v32, v64, v16, 0
    v_dot2_f32_bf16 v13, v68, v20, 0
    v_dot2_f32_bf16 v14, v72, v24, 0
    v_dot2_f32_bf16 v32, v65, v17, v32
    v_dot2_f32_bf16 v13, v69, v21, v13
    v_dot2_f32_bf16 v14, v73, v25, v14
    v_dot2_f32_bf16 v32, v66, v18, v32
    v_dot2_f32_bf16 v13, v70, v22, v13
    v_dot2_f32_bf16 v14, v74, v26, v14
    v_dot2_f32_bf16 v32, v67, v19, v32
    v_dot2_f32_bf16 v13, v71, v23, v13
    v_dot2_f32_bf16 v14, v75, v27, v14
    s_nop 2
    v_add_f32 v13, v13, v14
    v_add_f32 v32, v32, v13
    s_nop 1
    v_add_f32_dpp v32, v32, v32 quad_perm:[1,0,3,2] row_mask:0xf bank_mask:0xf
    s_nop 1
    v_add_f32_dpp v32, v32, v32 quad_perm:[2,3,0,1] row_mask:0xf bank_mask:0xf
    s_nop 1
    v_add_f32_dpp v32, v32, v32 row_half_mirror row_mask:0xf bank_mask:0xf
    v_cvt_pk_bf16_f32 v32, 0, v32
    v_mul_f32 v32, 0x3d93cd3a, v32
    v_cvt_pk_bf16_f32 v32, 0, v32
    v_dot2_f32_bf16 v33, v76, v16, 0
    v_dot2_f32_bf16 v13, v80, v20, 0
    v_dot2_f32_bf16 v14, v84, v24, 0
    v_dot2_f32_bf16 v33, v77, v17, v33
    v_dot2_f32_bf16 v13, v81, v21, v13
    v_dot2_f32_bf16 v14, v85, v25, v14
    v_dot2_f32_bf16 v33, v78, v18, v33
    v_dot2_f32_bf16 v13, v82, v22, v13
    v_dot2_f32_bf16 v14, v86, v26, v14
    v_dot2_f32_bf16 v33, v79, v19, v33
    v_dot2_f32_bf16 v13, v83, v23, v13
    v_dot2_f32_bf16 v14, v87, v27, v14
    s_nop 2
    v_add_f32 v13, v13, v14
    v_add_f32 v33, v33, v13
    s_nop 1
    v_add_f32_dpp v33, v33, v33 quad_perm:[1,0,3,2] row_mask:0xf bank_mask:0xf
    s_nop 1
    v_add_f32_dpp v33, v33, v33 quad_perm:[2,3,0,1] row_mask:0xf bank_mask:0xf
    s_nop 1
    v_add_f32_dpp v33, v33, v33 row_half_mirror row_mask:0xf bank_mask:0xf
    v_cvt_pk_bf16_f32 v33, 0, v33
    v_mul_f32 v33, 0x3d93cd3a, v33
    v_cvt_pk_bf16_f32 v33, 0, v33
    v_max_f32 v15, v32, v33
    s_addk_i32 s84, 3072
    s_cmp_eq_u32 s84, s34
    s_cselect_b32 s84, 0, s84
    s_sub_u32 s83, s83, 1
    s_cselect_b32 s83, 0, s83
    s_cselect_b32 s3, s31, s2
    s_bitcmp1_b32 s3, 1
    s_cselect_b64 vcc, -1, 0
    s_bitcmp1_b32 s3, 0
    s_waitcnt vmcnt(6)
    s_cbranch_vccnz L_hi45
    s_waitcnt vmcnt(4)
    s_cbranch_scc1 L_go45
    s_waitcnt vmcnt(3)
L_hi45:
    s_cbranch_scc1 L_go45
    s_waitcnt vmcnt(5)
L_go45:
    buffer_load_dwordx4 v[64:67], v12, s[32:35], s84 offen offset:0 nt
    s_bitcmp1_b32 s3, 0
    s_waitcnt vmcnt(6)
    s_cbranch_vccnz L_hi46
    s_waitcnt vmcnt(4)
    s_cbranch_scc1 L_go46
    s_waitcnt vmcnt(3)
L_hi46:
    s_cbranch_scc1 L_go46
    s_waitcnt vmcnt(5)
L_go46:
    buffer_load_dwordx4 v[68:71], v12, s[32:35], s84 offen offset:128 nt
    s_bitcmp1_b32 s3, 0
    s_waitcnt vmcnt(6)
    s_cbranch_vccnz L_hi47
    s_waitcnt vmcnt(4)
    s_cbranch_scc1 L_go47
    s_waitcnt vmcnt(3)
L_hi47:
    s_cbranch_scc1 L_go47
    s_waitcnt vmcnt(5)
L_go47:
    buffer_load_dwordx4 v[72:75], v12, s[32:35], s84 offen offset:256 nt
    v_dot2_f32_bf16 v34, v88, v16, 0
    v_dot2_f32_bf16 v13, v92, v20, 0
    v_dot2_f32_bf16 v14, v96, v24, 0
    v_dot2_f32_bf16 v34, v89, v17, v34
    v_dot2_f32_bf16 v13, v93, v21, v13
    v_dot2_f32_bf16 v14, v97, v25, v14
    v_dot2_f32_bf16 v34, v90, v18, v34
    v_dot2_f32_bf16 v13, v94, v22, v13
    v_dot2_f32_bf16 v14, v98, v26, v14
    v_dot2_f32_bf16 v34, v91, v19, v34
    v_dot2_f32_bf16 v13, v95, v23, v13
    v_dot2_f32_bf16 v14, v99, v27, v14
    s_nop 2
    v_add_f32 v13, v13, v14
    v_add_f32 v34, v34, v13
    s_nop 1
    v_add_f32_dpp v34, v34, v34 quad_perm:[1,0,3,2] row_mask:0xf bank_mask:0xf
    s_nop 1
    v_add_f32_dpp v34, v34, v34 quad_perm:[2,3,0,1] row_mask:0xf bank_mask:0xf
    s_nop 1
    v_add_f32_dpp v34, v34, v34 row_half_mirror row_mask:0xf bank_mask:0xf
    v_cvt_pk_bf16_f32 v34, 0, v34
    v_mul_f32 v34, 0x3d93cd3a, v34
    v_cvt_pk_bf16_f32 v34, 0, v34
    v_dot2_f32_bf16 v35, v100, v16, 0
    v_dot2_f32_bf16 v13, v104, v20, 0
    v_dot2_f32_bf16 v14, v108, v24, 0
    v_dot2_f32_bf16 v35, v101, v17, v35
    v_dot2_f32_bf16 v13, v105, v21, v13
    v_dot2_f32_bf16 v14, v109, v25, v14
    v_dot2_f32_bf16 v35, v102, v18, v35
    v_dot2_f32_bf16 v13, v106, v22, v13
    v_dot2_f32_bf16 v14, v110, v26, v14
    v_dot2_f32_bf16 v35, v103, v19, v35
    v_dot2_f32_bf16 v13, v107, v23, v13
    v_dot2_f32_bf16 v14, v111, v27, v14
    s_nop 2
    v_add_f32 v13, v13, v14
    v_add_f32 v35, v35, v13
    s_nop 1
    v_add_f32_dpp v35, v35, v35 quad_perm:[1,0,3,2] row_mask:0xf bank_mask:0xf
    s_nop 1
    v_add_f32_dpp v35, v35, v35 quad_perm:[2,3,0,1] row_mask:0xf bank_mask:0xf
    s_nop 1
    v_add_f32_dpp v35, v35, v35 row_half_mirror row_mask:0xf bank_mask:0xf
    v_cvt_pk_bf16_f32 v35, 0, v35
    v_mul_f32 v35, 0x3d93cd3a, v35
    v_cvt_pk_bf16_f32 v35, 0, v35
    v_max3_f32 v15, v15, v34, v35
    s_addk_i32 s84, 3072
    s_cmp_eq_u32 s84, s34
    s_cselect_b32 s84, 0, s84
    s_sub_u32 s83, s83, 1
    s_cselect_b32 s83, 0, s83
    s_cselect_b32 s3, s31, s2
    s_bitcmp1_b32 s3, 1
    s_cselect_b64 vcc, -1, 0
    s_bitcmp1_b32 s3, 0
    s_waitcnt vmcnt(6)
    s_cbranch_vccnz L_hi48
    s_waitcnt vmcnt(4)
    s_cbranch_scc1 L_go48
    s_waitcnt vmcnt(3)
L_hi48:
    s_cbranch_scc1 L_go48
    s_waitcnt vmcnt(5)
L_go48:
    buffer_load_dwordx4 v[76:79], v12, s[32:35], s84 offen offset:0 nt
    s_bitcmp1_b32 s3, 0
    s_waitcnt vmcnt(6)
    s_cbranch_vccnz L_hi49
    s_waitcnt vmcnt(4)
    s_cbranch_scc1 L_go49
    s_waitcnt vmcnt(3)
L_hi49:
    s_cbranch_scc1 L_go49
    s_waitcnt vmcnt(5)
L_go49:
    buffer_load_dwordx4 v[80:83], v12, s[32:35], s84 offen offset:128 nt
    s_bitcmp1_b32 s3, 0
    s_waitcnt vmcnt(6)
    s_cbranch_vccnz L_hi50
    s_waitcnt vmcnt(4)
    s_cbranch_scc1 L_go50
    s_waitcnt vmcnt(3)
L_hi50:
    s_cbranch_scc1 L_go50
    s_waitcnt vmcnt(5)
L_go50:
    buffer_load_dwordx4 v[84:87], v12, s[32:35], s84 offen offset:256 nt
    v_dot2_f32_bf16 v36, v112, v16, 0
    v_dot2_f32_bf16 v13, v116, v20, 0
    v_dot2_f32_bf16 v14, v120, v24, 0
    v_dot2_f32_bf16 v36, v113, v17, v36
    v_dot2_f32_bf16 v13, v117, v21, v13
    v_dot2_f32_bf16 v14, v121, v25, v14
    v_dot2_f32_bf16 v36, v114, v18, v36
    v_dot2_f32_bf16 v13, v118, v22, v13
    v_dot2_f32_bf16 v14, v122, v26, v14
    v_dot2_f32_bf16 v36, v115, v19, v36
    v_dot2_f32_bf16 v13, v119, v23, v13
    v_dot2_f32_bf16 v14, v123, v27, v14
    s_nop 2
    v_add_f32 v13, v13, v14
    v_add_f32 v36, v36, v13
    s_nop 1
    v_add_f32_dpp v36, v36, v36 quad_perm:[1,0,3,2] row_mask:0xf bank_mask:0xf
    s_nop 1
    v_add_f32_dpp v36, v36, v36 quad_perm:[2,3,0,1] row_mask:0xf bank_mask:0xf
    s_nop 1
    v_add_f32_dpp v36, v36, v36 row_half_mirror row_mask:0xf bank_mask:0xf
    v_cvt_pk_bf16_f32 v36, 0, v36
    v_mul_f32 v36, 0x3d93cd3a, v36
    v_cvt_pk_bf16_f32 v36, 0, v36
    v_dot2_f32_bf16 v37, v124, v16, 0
    v_dot2_f32_bf16 v13, v128, v20, 0
    v_dot2_f32_bf16 v14, v132, v24, 0
    v_dot2_f32_bf16 v37, v125, v17, v37
    v_dot2_f32_bf16 v13, v129, v21, v13
    v_dot2_f32_bf16 v14, v133, v25, v14
    v_dot2_f32_bf16 v37, v126, v18, v37
    v_dot2_f32_bf16 v13, v130, v22, v13
    v_dot2_f32_bf16 v14, v134, v26, v14
    v_dot2_f32_bf16 v37, v127, v19, v37
    v_dot2_f32_bf16 v13, v131, v23, v13
    v_dot2_f32_bf16 v14, v135, v27, v14
    s_nop 2
    v_add_f32 v13, v13, v14
    v_add_f32 v37, v37, v13
    s_nop 1
    v_add_f32_dpp v37, v37, v37 quad_perm:[1,0,3,2] row_mask:0xf bank_mask:0xf
    s_nop 1
    v_add_f32_dpp v37, v37, v37 quad_perm:[2,3,0,1] row_mask:0xf bank_mask:0xf
    s_nop 1
    v_add_f32_dpp v37, v37, v37 row_half_mirror row_mask:0xf bank_mask:0xf
    v_cvt_pk_bf16_f32 v37, 0, v37
    v_mul_f32 v37, 0x3d93cd3a, v37
    v_cvt_pk_bf16_f32 v37, 0, v37
    v_max3_f32 v15, v15, v36, v37
    s_addk_i32 s84, 3072
    s_cmp_eq_u32 s84, s34
    s_cselect_b32 s84, 0, s84
    s_sub_u32 s83, s83, 1
    s_cselect_b32 s83, 0, s83
    s_cselect_b32 s3, s31, s2
    s_bitcmp1_b32 s3, 1
    s_cselect_b64 vcc, -1, 0
    s_bitcmp1_b32 s3, 0
    s_waitcnt vmcnt(6)
    s_cbranch_vccnz L_hi51
    s_waitcnt vmcnt(4)
    s_cbranch_scc1 L_go51
    s_waitcnt vmcnt(3)
L_hi51:
    s_cbranch_scc1 L_go51
    s_waitcnt vmcnt(5)
L_go51:
    buffer_load_dwordx4 v[88:91], v12, s[32:35], s84 offen offset:0 nt
    s_bitcmp1_b32 s3, 0
    s_waitcnt vmcnt(6)
    s_cbranch_vccnz L_hi52
    s_waitcnt vmcnt(4)
    s_cbranch_scc1 L_go52
    s_waitcnt vmcnt(3)
L_hi52:
    s_cbranch_scc1 L_go52
    s_waitcnt vmcnt(5)
L_go52:
    buffer_load_dwordx4 v[92:95], v12, s[32:35], s84 offen offset:128 nt
    s_bitcmp1_b32 s3, 0
    s_waitcnt vmcnt(6)
    s_cbranch_vccnz L_hi53
    s_waitcnt vmcnt(4)
    s_cbranch_scc1 L_go53
    s_waitcnt vmcnt(3)
L_hi53:
    s_cbranch_scc1 L_go53
    s_waitcnt vmcnt(5)
L_go53:
    buffer_load_dwordx4 v[96:99], v12, s[32:35], s84 offen offset:256 nt
    v_mov_b32 v13, 0
    ds_read_b32 v13, v13 offset:10816
    s_waitcnt lgkmcnt(0)
    v_readfirstlane_b32 s63, v13
    s_cmp_eq_u32 s63, 0
    s_cselect_b32 s63, 16, s63
    s_cmp_eq_u32 s26, 0
    s_cselect_b32 s64, 4, 0
    s_sub_i32 s63, s63, s64
    s_sub_i32 s64, 16, s63
    s_max_i32 s64, s64, 0
    s_sub_i32 s65, s63, 20
    s_max_i32 s65, s65, 0
    s_cmp_lg_u32 s65, 0
    s_cselect_b32 s66, 1, -1
    s_add_i32 s2, s31, s66
    s_min_u32 s2, s2, 3
    s_add_u32 s64, s64, s65
    s_mul_i32 s83, s64, 2
    s_lshr_b32 s83, s83, 2
    v_dot2_f32_bf16 v38, v136, v16, 0
    v_dot2_f32_bf16 v13, v140, v20, 0
    v_dot2_f32_bf16 v14, v144, v24, 0
    v_dot2_f32_bf16 v38, v137, v17, v38
    v_dot2_f32_bf16 v13, v141, v21, v13
    v_dot2_f32_bf16 v14, v145, v25, v14
    v_dot2_f32_bf16 v38, v138, v18, v38
    v_dot2_f32_bf16 v13, v142, v22, v13
    v_dot2_f32_bf16 v14, v146, v26, v14
    v_dot2_f32_bf16 v38, v139, v19, v38
    v_dot2_f32_bf16 v13, v143, v23, v13
    v_dot2_f32_bf16 v14, v147, v27, v14
    s_nop 2
    v_add_f32 v13, v13, v14
    v_add_f32 v38, v38, v13
    s_nop 1
    v_add_f32_dpp v38, v38, v38 quad_perm:[1,0,3,2] row_mask:0xf bank_mask:0xf
    s_nop 1
    v_add_f32_dpp v38, v38, v38 quad_perm:[2,3,0,1] row_mask:0xf bank_mask:0xf
    s_nop 1
    v_add_f32_dpp v38, v38, v38 row_half_mirror row_mask:0xf bank_mask:0xf
    v_cvt_pk_bf16_f32 v38, 0, v38
    v_mul_f32 v38, 0x3d93cd3a, v38
    v_cvt_pk_bf16_f32 v38, 0, v38
    v_dot2_f32_bf16 v39, v148, v16, 0
    v_dot2_f32_bf16 v13, v152, v20, 0
    v_dot2_f32_bf16 v14, v156, v24, 0
    v_dot2_f32_bf16 v39, v149, v17, v39
    v_dot2_f32_bf16 v13, v153, v21, v13
    v_dot2_f32_bf16 v14, v157, v25, v14
    v_dot2_f32_bf16 v39, v150, v18, v39
    v_dot2_f32_bf16 v13, v154, v22, v13
    v_dot2_f32_bf16 v14, v158, v26, v14
    v_dot2_f32_bf16 v39, v151, v19, v39
    v_dot2_f32_bf16 v13, v155, v23, v13
    v_dot2_f32_bf16 v14, v159, v27, v14
    s_nop 2
    v_add_f32 v13, v13, v14
    v_add_f32 v39, v39, v13
    s_nop 1
    v_add_f32_dpp v39, v39, v39 quad_perm:[1,0,3,2] row_mask:0xf bank_mask:0xf
    s_nop 1
    v_add_f32_dpp v39, v39, v39 quad_perm:[2,3,0,1] row_mask:0xf bank_mask:0xf
    s_nop 1
    v_add_f32_dpp v39, v39, v39 row_half_mirror row_mask:0xf bank_mask:0xf
    v_cvt_pk_bf16_f32 v39, 0, v39
    v_mul_f32 v39, 0x3d93cd3a, v39
    v_cvt_pk_bf16_f32 v39, 0, v39
    v_max3_f32 v15, v15, v38, v39
    s_addk_i32 s84, 3072
    s_cmp_eq_u32 s84, s34
    s_cselect_b32 s84, 0, s84
    s_sub_u32 s83, s83, 1
    s_cselect_b32 s83, 0, s83
    s_cselect_b32 s3, s31, s2
    s_bitcmp1_b32 s3, 1
    s_cselect_b64 vcc, -1, 0
    s_bitcmp1_b32 s3, 0
    s_waitcnt vmcnt(6)
    s_cbranch_vccnz L_hi54
    s_waitcnt vmcnt(4)
    s_cbranch_scc1 L_go54
    s_waitcnt vmcnt(3)
L_hi54:
    s_cbranch_scc1 L_go54
    s_waitcnt vmcnt(5)
L_go54:
    buffer_load_dwordx4 v[100:103], v12, s[32:35], s84 offen offset:0 nt
    s_bitcmp1_b32 s3, 0
    s_waitcnt vmcnt(6)
    s_cbranch_vccnz L_hi55
    s_waitcnt vmcnt(4)
    s_cbranch_scc1 L_go55
    s_waitcnt vmcnt(3)
L_hi55:
    s_cbranch_scc1 L_go55
    s_waitcnt vmcnt(5)
L_go55:
    buffer_load_dwordx4 v[104:107], v12, s[32:35], s84 offen offset:128 nt
    s_bitcmp1_b32 s3, 0
    s_waitcnt vmcnt(6)
    s_cbranch_vccnz L_hi56
    s_waitcnt vmcnt(4)
    s_cbranch_scc1 L_go56
    s_waitcnt vmcnt(3)
L_hi56:
    s_cbranch_scc1 L_go56
    s_waitcnt vmcnt(5)
L_go56:
    buffer_load_dwordx4 v[108:111], v12, s[32:35], s84 offen offset:256 nt
    v_dot2_f32_bf16 v40, v160, v16, 0
    v_dot2_f32_bf16 v13, v164, v20, 0
    v_dot2_f32_bf16 v14, v168, v24, 0
    v_dot2_f32_bf16 v40, v161, v17, v40
    v_dot2_f32_bf16 v13, v165, v21, v13
    v_dot2_f32_bf16 v14, v169, v25, v14
    v_dot2_f32_bf16 v40, v162, v18, v40
    v_dot2_f32_bf16 v13, v166, v22, v13
    v_dot2_f32_bf16 v14, v170, v26, v14
    v_dot2_f32_bf16 v40, v163, v19, v40
    v_dot2_f32_bf16 v13, v167, v23, v13
    v_dot2_f32_bf16 v14, v171, v27, v14
    s_nop 2
    v_add_f32 v13, v13, v14
    v_add_f32 v40, v40, v13
    s_nop 1
    v_add_f32_dpp v40, v40, v40 quad_perm:[1,0,3,2] row_mask:0xf bank_mask:0xf
    s_nop 1
    v_add_f32_dpp v40, v40, v40 quad_perm:[2,3,0,1] row_mask:0xf bank_mask:0xf
    s_nop 1
    v_add_f32_dpp v40, v40, v40 row_half_mirror row_mask:0xf bank_mask:0xf
    v_cvt_pk_bf16_f32 v40, 0, v40
    v_mul_f32 v40, 0x3d93cd3a, v40
    v_cvt_pk_bf16_f32 v40, 0, v40
    v_dot2_f32_bf16 v41, v172, v16, 0
    v_dot2_f32_bf16 v13, v176, v20, 0
    v_dot2_f32_bf16 v14, v180, v24, 0
    v_dot2_f32_bf16 v41, v173, v17, v41
    v_dot2_f32_bf16 v13, v177, v21, v13
    v_dot2_f32_bf16 v14, v181, v25, v14
    v_dot2_f32_bf16 v41, v174, v18, v41
    v_dot2_f32_bf16 v13, v178, v22, v13
    v_dot2_f32_bf16 v14, v182, v26, v14
    v_dot2_f32_bf16 v41, v175, v19, v41
    v_dot2_f32_bf16 v13, v179, v23, v13
    v_dot2_f32_bf16 v14, v183, v27, v14
    s_nop 2
    v_add_f32 v13, v13, v14
    v_add_f32 v41, v41, v13
    s_nop 1
    v_add_f32_dpp v41, v41, v41 quad_perm:[1,0,3,2] row_mask:0xf bank_mask:0xf
    s_nop 1
    v_add_f32_dpp v41, v41, v41 quad_perm:[2,3,0,1] row_mask:0xf bank_mask:0xf
    s_nop 1
    v_add_f32_dpp v41, v41, v41 row_half_mirror row_mask:0xf bank_mask:0xf
    v_cvt_pk_bf16_f32 v41, 0, v41
    v_mul_f32 v41, 0x3d93cd3a, v41
    v_cvt_pk_bf16_f32 v41, 0, v41
    v_max3_f32 v15, v15, v40, v41
    s_addk_i32 s84, 3072
    s_cmp_eq_u32 s84, s34
    s_cselect_b32 s84, 0, s84
    s_sub_u32 s83, s83, 1
    s_cselect_b32 s83, 0, s83
    s_cselect_b32 s3, s31, s2
    s_bitcmp1_b32 s3, 1
    s_cselect_b64 vcc, -1, 0
    s_bitcmp1_b32 s3, 0
    s_waitcnt vmcnt(6)
    s_cbranch_vccnz L_hi57
    s_waitcnt vmcnt(4)
    s_cbranch_scc1 L_go57
    s_waitcnt vmcnt(3)
L_hi57:
    s_cbranch_scc1 L_go57
    s_waitcnt vmcnt(5)
L_go57:
    buffer_load_dwordx4 v[112:115], v12, s[32:35], s84 offen offset:0 nt
    s_bitcmp1_b32 s3, 0
    s_waitcnt vmcnt(6)
    s_cbranch_vccnz L_hi58
    s_waitcnt vmcnt(4)
    s_cbranch_scc1 L_go58
    s_waitcnt vmcnt(3)
L_hi58:
    s_cbranch_scc1 L_go58
    s_waitcnt vmcnt(5)
L_go58:
    buffer_load_dwordx4 v[116:119], v12, s[32:35], s84 offen offset:128 nt
    s_bitcmp1_b32 s3, 0
    s_waitcnt vmcnt(6)
    s_cbranch_vccnz L_hi59
    s_waitcnt vmcnt(4)
    s_cbranch_scc1 L_go59
    s_waitcnt vmcnt(3)
L_hi59:
    s_cbranch_scc1 L_go59
    s_waitcnt vmcnt(5)
L_go59:
    buffer_load_dwordx4 v[120:123], v12, s[32:35], s84 offen offset:256 nt
    v_dot2_f32_bf16 v42, v184, v16, 0
    v_dot2_f32_bf16 v13, v188, v20, 0
    v_dot2_f32_bf16 v14, v192, v24, 0
    v_dot2_f32_bf16 v42, v185, v17, v42
    v_dot2_f32_bf16 v13, v189, v21, v13
    v_dot2_f32_bf16 v14, v193, v25, v14
    v_dot2_f32_bf16 v42, v186, v18, v42
    v_dot2_f32_bf16 v13, v190, v22, v13
    v_dot2_f32_bf16 v14, v194, v26, v14
    v_dot2_f32_bf16 v42, v187, v19, v42
    v_dot2_f32_bf16 v13, v191, v23, v13
    v_dot2_f32_bf16 v14, v195, v27, v14
    s_nop 2
    v_add_f32 v13, v13, v14
    v_add_f32 v42, v42, v13
    s_nop 1
    v_add_f32_dpp v42, v42, v42 quad_perm:[1,0,3,2] row_mask:0xf bank_mask:0xf
    s_nop 1
    v_add_f32_dpp v42, v42, v42 quad_perm:[2,3,0,1] row_mask:0xf bank_mask:0xf
    s_nop 1
    v_add_f32_dpp v42, v42, v42 row_half_mirror row_mask:0xf bank_mask:0xf
    v_cvt_pk_bf16_f32 v42, 0, v42
    v_mul_f32 v42, 0x3d93cd3a, v42
    v_cvt_pk_bf16_f32 v42, 0, v42
    v_dot2_f32_bf16 v43, v196, v16, 0
    v_dot2_f32_bf16 v13, v200, v20, 0
    v_dot2_f32_bf16 v14, v204, v24, 0
    v_dot2_f32_bf16 v43, v197, v17, v43
    v_dot2_f32_bf16 v13, v201, v21, v13
    v_dot2_f32_bf16 v14, v205, v25, v14
    v_dot2_f32_bf16 v43, v198, v18, v43
    v_dot2_f32_bf16 v13, v202, v22, v13
    v_dot2_f32_bf16 v14, v206, v26, v14
    v_dot2_f32_bf16 v43, v199, v19, v43
    v_dot2_f32_bf16 v13, v203, v23, v13
    v_dot2_f32_bf16 v14, v207, v27, v14
    s_nop 2
    v_add_f32 v13, v13, v14
    v_add_f32 v43, v43, v13
    s_nop 1
    v_add_f32_dpp v43, v43, v43 quad_perm:[1,0,3,2] row_mask:0xf bank_mask:0xf
    s_nop 1
    v_add_f32_dpp v43, v43, v43 quad_perm:[2,3,0,1] row_mask:0xf bank_mask:0xf
    s_nop 1
    v_add_f32_dpp v43, v43, v43 row_half_mirror row_mask:0xf bank_mask:0xf
    v_cvt_pk_bf16_f32 v43, 0, v43
    v_mul_f32 v43, 0x3d93cd3a, v43
    v_cvt_pk_bf16_f32 v43, 0, v43
    v_max3_f32 v15, v15, v42, v43
    s_addk_i32 s84, 3072
    s_cmp_eq_u32 s84, s34
    s_cselect_b32 s84, 0, s84
    s_sub_u32 s83, s83, 1
    s_cselect_b32 s83, 0, s83
    s_cselect_b32 s3, s31, s2
    s_bitcmp1_b32 s3, 1
    s_cselect_b64 vcc, -1, 0
    s_bitcmp1_b32 s3, 0
    s_waitcnt vmcnt(6)
    s_cbranch_vccnz L_hi60
    s_waitcnt vmcnt(4)
    s_cbranch_scc1 L_go60
    s_waitcnt vmcnt(3)
L_hi60:
    s_cbranch_scc1 L_go60
    s_waitcnt vmcnt(5)
L_go60:
    buffer_load_dwordx4 v[124:127], v12, s[32:35], s84 offen offset:0 nt
    s_bitcmp1_b32 s3, 0
    s_waitcnt vmcnt(6)
    s_cbranch_vccnz L_hi61
    s_waitcnt vmcnt(4)
    s_cbranch_scc1 L_go61
    s_waitcnt vmcnt(3)
L_hi61:
    s_cbranch_scc1 L_go61
    s_waitcnt vmcnt(5)
L_go61:
    buffer_load_dwordx4 v[128:131], v12, s[32:35], s84 offen offset:128 nt
    s_bitcmp1_b32 s3, 0
    s_waitcnt vmcnt(6)
    s_cbranch_vccnz L_hi62
    s_waitcnt vmcnt(4)
    s_cbranch_scc1 L_go62
    s_waitcnt vmcnt(3)
L_hi62:
    s_cbranch_scc1 L_go62
    s_waitcnt vmcnt(5)
L_go62:
    buffer_load_dwordx4 v[132:135], v12, s[32:35], s84 offen offset:256 nt
    v_dot2_f32_bf16 v44, v208, v16, 0
    v_dot2_f32_bf16 v13, v212, v20, 0
    v_dot2_f32_bf16 v14, v216, v24, 0
    v_dot2_f32_bf16 v44, v209, v17, v44
    v_dot2_f32_bf16 v13, v213, v21, v13
    v_dot2_f32_bf16 v14, v217, v25, v14
    v_dot2_f32_bf16 v44, v210, v18, v44
    v_dot2_f32_bf16 v13, v214, v22, v13
    v_dot2_f32_bf16 v14, v218, v26, v14
    v_dot2_f32_bf16 v44, v211, v19, v44
    v_dot2_f32_bf16 v13, v215, v23, v13
    v_dot2_f32_bf16 v14, v219, v27, v14
    s_nop 2
    v_add_f32 v13, v13, v14
    v_add_f32 v44, v44, v13
    s_nop 1
    v_add_f32_dpp v44, v44, v44 quad_perm:[1,0,3,2] row_mask:0xf bank_mask:0xf
    s_nop 1
    v_add_f32_dpp v44, v44, v44 quad_perm:[2,3,0,1] row_mask:0xf bank_mask:0xf
    s_nop 1
    v_add_f32_dpp v44, v44, v44 row_half_mirror row_mask:0xf bank_mask:0xf
    v_cvt_pk_bf16_f32 v44, 0, v44
    v_mul_f32 v44, 0x3d93cd3a, v44
    v_cvt_pk_bf16_f32 v44, 0, v44
    v_dot2_f32_bf16 v45, v220, v16, 0
    v_dot2_f32_bf16 v13, v224, v20, 0
    v_dot2_f32_bf16 v14, v228, v24, 0
    v_dot2_f32_bf16 v45, v221, v17, v45
    v_dot2_f32_bf16 v13, v225, v21, v13
    v_dot2_f32_bf16 v14, v229, v25, v14
    v_dot2_f32_bf16 v45, v222, v18, v45
    v_dot2_f32_bf16 v13, v226, v22, v13
    v_dot2_f32_bf16 v14, v230, v26, v14
    v_dot2_f32_bf16 v45, v223, v19, v45
    v_dot2_f32_bf16 v13, v227, v23, v13
    v_dot2_f32_bf16 v14, v231, v27, v14
    s_nop 2
    v_add_f32 v13, v13, v14
    v_add_f32 v45, v45, v13
    s_nop 1
    v_add_f32_dpp v45, v45, v45 quad_perm:[1,0,3,2] row_mask:0xf bank_mask:0xf
    s_nop 1
    v_add_f32_dpp v45, v45, v45 quad_perm:[2,3,0,1] row_mask:0xf bank_mask:0xf
    s_nop 1
    v_add_f32_dpp v45, v45, v45 row_half_mirror row_mask:0xf bank_mask:0xf
    v_cvt_pk_bf16_f32 v45, 0, v45
    v_mul_f32 v45, 0x3d93cd3a, v45
    v_cvt_pk_bf16_f32 v45, 0, v45
    v_max3_f32 v15, v15, v44, v45
    s_addk_i32 s84, 3072
    s_cmp_eq_u32 s84, s34
    s_cselect_b32 s84, 0, s84
    s_sub_u32 s83, s83, 1
    s_cselect_b32 s83, 0, s83
    s_cselect_b32 s3, s31, s2
    s_bitcmp1_b32 s3, 1
    s_cselect_b64 vcc, -1, 0
    s_bitcmp1_b32 s3, 0
    s_waitcnt vmcnt(6)
    s_cbranch_vccnz L_hi63
    s_waitcnt vmcnt(4)
    s_cbranch_scc1 L_go63
    s_waitcnt vmcnt(3)
L_hi63:
    s_cbranch_scc1 L_go63
    s_waitcnt vmcnt(5)
L_go63:
    buffer_load_dwordx4 v[136:139], v12, s[32:35], s84 offen offset:0 nt
    s_bitcmp1_b32 s3, 0
    s_waitcnt vmcnt(6)
    s_cbranch_vccnz L_hi64
    s_waitcnt vmcnt(4)
    s_cbranch_scc1 L_go64
    s_waitcnt vmcnt(3)
L_hi64:
    s_cbranch_scc1 L_go64
    s_waitcnt vmcnt(5)
L_go64:
    buffer_load_dwordx4 v[140:143], v12, s[32:35], s84 offen offset:128 nt
    s_bitcmp1_b32 s3, 0
    s_waitcnt vmcnt(6)
    s_cbranch_vccnz L_hi65
    s_waitcnt vmcnt(4)
    s_cbranch_scc1 L_go65
    s_waitcnt vmcnt(3)
L_hi65:
    s_cbranch_scc1 L_go65
    s_waitcnt vmcnt(5)
L_go65:
    buffer_load_dwordx4 v[144:147], v12, s[32:35], s84 offen offset:256 nt
    v_dot2_f32_bf16 v46, v232, v16, 0
    v_dot2_f32_bf16 v13, v236, v20, 0
    v_dot2_f32_bf16 v14, v240, v24, 0
    v_dot2_f32_bf16 v46, v233, v17, v46
    v_dot2_f32_bf16 v13, v237, v21, v13
    v_dot2_f32_bf16 v14, v241, v25, v14
    v_dot2_f32_bf16 v46, v234, v18, v46
    v_dot2_f32_bf16 v13, v238, v22, v13
    v_dot2_f32_bf16 v14, v242, v26, v14
    v_dot2_f32_bf16 v46, v235, v19, v46
    v_dot2_f32_bf16 v13, v239, v23, v13
    v_dot2_f32_bf16 v14, v243, v27, v14
    s_nop 2
    v_add_f32 v13, v13, v14
    v_add_f32 v46, v46, v13
    s_nop 1
    v_add_f32_dpp v46, v46, v46 quad_perm:[1,0,3,2] row_mask:0xf bank_mask:0xf
    s_nop 1
    v_add_f32_dpp v46, v46, v46 quad_perm:[2,3,0,1] row_mask:0xf bank_mask:0xf
    s_nop 1
    v_add_f32_dpp v46, v46, v46 row_half_mirror row_mask:0xf bank_mask:0xf
    v_cvt_pk_bf16_f32 v46, 0, v46
    v_mul_f32 v46, 0x3d93cd3a, v46
    v_cvt_pk_bf16_f32 v46, 0, v46
    v_dot2_f32_bf16 v47, v244, v16, 0
    v_dot2_f32_bf16 v13, v248, v20, 0
    v_dot2_f32_bf16 v14, v252, v24, 0
    v_dot2_f32_bf16 v47, v245, v17, v47
    v_dot2_f32_bf16 v13, v249, v21, v13
    v_dot2_f32_bf16 v14, v253, v25, v14
    v_dot2_f32_bf16 v47, v246, v18, v47
    v_dot2_f32_bf16 v13, v250, v22, v13
    v_dot2_f32_bf16 v14, v254, v26, v14
    v_dot2_f32_bf16 v47, v247, v19, v47
    v_dot2_f32_bf16 v13, v251, v23, v13
    v_dot2_f32_bf16 v14, v255, v27, v14
    s_nop 2
    v_add_f32 v13, v13, v14
    v_add_f32 v47, v47, v13
    s_nop 1
    v_add_f32_dpp v47, v47, v47 quad_perm:[1,0,3,2] row_mask:0xf bank_mask:0xf
    s_nop 1
    v_add_f32_dpp v47, v47, v47 quad_perm:[2,3,0,1] row_mask:0xf bank_mask:0xf
    s_nop 1
    v_add_f32_dpp v47, v47, v47 row_half_mirror row_mask:0xf bank_mask:0xf
    v_cvt_pk_bf16_f32 v47, 0, v47
    v_mul_f32 v47, 0x3d93cd3a, v47
    v_cvt_pk_bf16_f32 v47, 0, v47
    v_max3_f32 v15, v15, v46, v47
    s_addk_i32 s84, 3072
    s_cmp_eq_u32 s84, s34
    s_cselect_b32 s84, 0, s84
    s_sub_u32 s83, s83, 1
    s_cselect_b32 s83, 0, s83
    s_cselect_b32 s3, s31, s2
    s_bitcmp1_b32 s3, 1
    s_cselect_b64 vcc, -1, 0
    s_bitcmp1_b32 s3, 0
    s_waitcnt vmcnt(6)
    s_cbranch_vccnz L_hi66
    s_waitcnt vmcnt(4)
    s_cbranch_scc1 L_go66
    s_waitcnt vmcnt(3)
L_hi66:
    s_cbranch_scc1 L_go66
    s_waitcnt vmcnt(5)
L_go66:
    buffer_load_dwordx4 v[148:151], v12, s[32:35], s84 offen offset:0 nt
    s_bitcmp1_b32 s3, 0
    s_waitcnt vmcnt(6)
    s_cbranch_vccnz L_hi67
    s_waitcnt vmcnt(4)
    s_cbranch_scc1 L_go67
    s_waitcnt vmcnt(3)
L_hi67:
    s_cbranch_scc1 L_go67
    s_waitcnt vmcnt(5)
L_go67:
    buffer_load_dwordx4 v[152:155], v12, s[32:35], s84 offen offset:128 nt
    s_bitcmp1_b32 s3, 0
    s_waitcnt vmcnt(6)
    s_cbranch_vccnz L_hi68
    s_waitcnt vmcnt(4)
    s_cbranch_scc1 L_go68
    s_waitcnt vmcnt(3)
L_hi68:
    s_cbranch_scc1 L_go68
    s_waitcnt vmcnt(5)
L_go68:
    buffer_load_dwordx4 v[156:159], v12, s[32:35], s84 offen offset:256 nt
    v_dot2_f32_bf16 v48, v64, v16, 0
    v_dot2_f32_bf16 v13, v68, v20, 0
    v_dot2_f32_bf16 v14, v72, v24, 0
    v_dot2_f32_bf16 v48, v65, v17, v48
    v_dot2_f32_bf16 v13, v69, v21, v13
    v_dot2_f32_bf16 v14, v73, v25, v14
    v_dot2_f32_bf16 v48, v66, v18, v48
    v_dot2_f32_bf16 v13, v70, v22, v13
    v_dot2_f32_bf16 v14, v74, v26, v14
    v_dot2_f32_bf16 v48, v67, v19, v48
    v_dot2_f32_bf16 v13, v71, v23, v13
    v_dot2_f32_bf16 v14, v75, v27, v14
    s_nop 2
    v_add_f32 v13, v13, v14
    v_add_f32 v48, v48, v13
    s_nop 1
    v_add_f32_dpp v48, v48, v48 quad_perm:[1,0,3,2] row_mask:0xf bank_mask:0xf
    s_nop 1
    v_add_f32_dpp v48, v48, v48 quad_perm:[2,3,0,1] row_mask:0xf bank_mask:0xf
    s_nop 1
    v_add_f32_dpp v48, v48, v48 row_half_mirror row_mask:0xf bank_mask:0xf
    v_cvt_pk_bf16_f32 v48, 0, v48
    v_mul_f32 v48, 0x3d93cd3a, v48
    v_cvt_pk_bf16_f32 v48, 0, v48
    v_dot2_f32_bf16 v49, v76, v16, 0
    v_dot2_f32_bf16 v13, v80, v20, 0
    v_dot2_f32_bf16 v14, v84, v24, 0
    v_dot2_f32_bf16 v49, v77, v17, v49
    v_dot2_f32_bf16 v13, v81, v21, v13
    v_dot2_f32_bf16 v14, v85, v25, v14
    v_dot2_f32_bf16 v49, v78, v18, v49
    v_dot2_f32_bf16 v13, v82, v22, v13
    v_dot2_f32_bf16 v14, v86, v26, v14
    v_dot2_f32_bf16 v49, v79, v19, v49
    v_dot2_f32_bf16 v13, v83, v23, v13
    v_dot2_f32_bf16 v14, v87, v27, v14
    s_nop 2
    v_add_f32 v13, v13, v14
    v_add_f32 v49, v49, v13
    s_nop 1
    v_add_f32_dpp v49, v49, v49 quad_perm:[1,0,3,2] row_mask:0xf bank_mask:0xf
    s_nop 1
    v_add_f32_dpp v49, v49, v49 quad_perm:[2,3,0,1] row_mask:0xf bank_mask:0xf
    s_nop 1
    v_add_f32_dpp v49, v49, v49 row_half_mirror row_mask:0xf bank_mask:0xf
    v_cvt_pk_bf16_f32 v49, 0, v49
    v_mul_f32 v49, 0x3d93cd3a, v49
    v_cvt_pk_bf16_f32 v49, 0, v49
    v_max3_f32 v15, v15, v48, v49
    s_addk_i32 s84, 3072
    s_cmp_eq_u32 s84, s34
    s_cselect_b32 s84, 0, s84
    s_sub_u32 s83, s83, 1
    s_cselect_b32 s83, 0, s83
    s_cselect_b32 s3, s31, s2
    s_bitcmp1_b32 s3, 1
    s_cselect_b64 vcc, -1, 0
    s_bitcmp1_b32 s3, 0
    s_waitcnt vmcnt(6)
    s_cbranch_vccnz L_hi69
    s_waitcnt vmcnt(4)
    s_cbranch_scc1 L_go69
    s_waitcnt vmcnt(3)
L_hi69:
    s_cbranch_scc1 L_go69
    s_waitcnt vmcnt(5)
L_go69:
    buffer_load_dwordx4 v[64:67], v12, s[32:35], s84 offen offset:0 nt
    s_bitcmp1_b32 s3, 0
    s_waitcnt vmcnt(6)
    s_cbranch_vccnz L_hi70
    s_waitcnt vmcnt(4)
    s_cbranch_scc1 L_go70
    s_waitcnt vmcnt(3)
L_hi70:
    s_cbranch_scc1 L_go70
    s_waitcnt vmcnt(5)
L_go70:
    buffer_load_dwordx4 v[68:71], v12, s[32:35], s84 offen offset:128 nt
    s_bitcmp1_b32 s3, 0
    s_waitcnt vmcnt(6)
    s_cbranch_vccnz L_hi71
    s_waitcnt vmcnt(4)
    s_cbranch_scc1 L_go71
    s_waitcnt vmcnt(3)
L_hi71:
    s_cbranch_scc1 L_go71
    s_waitcnt vmcnt(5)
L_go71:
    buffer_load_dwordx4 v[72:75], v12, s[32:35], s84 offen offset:256 nt
    v_dot2_f32_bf16 v50, v88, v16, 0
    v_dot2_f32_bf16 v13, v92, v20, 0
    v_dot2_f32_bf16 v14, v96, v24, 0
    v_dot2_f32_bf16 v50, v89, v17, v50
    v_dot2_f32_bf16 v13, v93, v21, v13
    v_dot2_f32_bf16 v14, v97, v25, v14
    v_dot2_f32_bf16 v50, v90, v18, v50
    v_dot2_f32_bf16 v13, v94, v22, v13
    v_dot2_f32_bf16 v14, v98, v26, v14
    v_dot2_f32_bf16 v50, v91, v19, v50
    v_dot2_f32_bf16 v13, v95, v23, v13
    v_dot2_f32_bf16 v14, v99, v27, v14
    s_nop 2
    v_add_f32 v13, v13, v14
    v_add_f32 v50, v50, v13
    s_nop 1
    v_add_f32_dpp v50, v50, v50 quad_perm:[1,0,3,2] row_mask:0xf bank_mask:0xf
    s_nop 1
    v_add_f32_dpp v50, v50, v50 quad_perm:[2,3,0,1] row_mask:0xf bank_mask:0xf
    s_nop 1
    v_add_f32_dpp v50, v50, v50 row_half_mirror row_mask:0xf bank_mask:0xf
    v_cvt_pk_bf16_f32 v50, 0, v50
    v_mul_f32 v50, 0x3d93cd3a, v50
    v_cvt_pk_bf16_f32 v50, 0, v50
    v_dot2_f32_bf16 v51, v100, v16, 0
    v_dot2_f32_bf16 v13, v104, v20, 0
    v_dot2_f32_bf16 v14, v108, v24, 0
    v_dot2_f32_bf16 v51, v101, v17, v51
    v_dot2_f32_bf16 v13, v105, v21, v13
    v_dot2_f32_bf16 v14, v109, v25, v14
    v_dot2_f32_bf16 v51, v102, v18, v51
    v_dot2_f32_bf16 v13, v106, v22, v13
    v_dot2_f32_bf16 v14, v110, v26, v14
    v_dot2_f32_bf16 v51, v103, v19, v51
    v_dot2_f32_bf16 v13, v107, v23, v13
    v_dot2_f32_bf16 v14, v111, v27, v14
    s_nop 2
    v_add_f32 v13, v13, v14
    v_add_f32 v51, v51, v13
    s_nop 1
    v_add_f32_dpp v51, v51, v51 quad_perm:[1,0,3,2] row_mask:0xf bank_mask:0xf
    s_nop 1
    v_add_f32_dpp v51, v51, v51 quad_perm:[2,3,0,1] row_mask:0xf bank_mask:0xf
    s_nop 1
    v_add_f32_dpp v51, v51, v51 row_half_mirror row_mask:0xf bank_mask:0xf
    v_cvt_pk_bf16_f32 v51, 0, v51
    v_mul_f32 v51, 0x3d93cd3a, v51
    v_cvt_pk_bf16_f32 v51, 0, v51
    v_max3_f32 v15, v15, v50, v51
    s_addk_i32 s84, 3072
    s_cmp_eq_u32 s84, s34
    s_cselect_b32 s84, 0, s84
    s_sub_u32 s83, s83, 1
    s_cselect_b32 s83, 0, s83
    s_cselect_b32 s3, s31, s2
    s_bitcmp1_b32 s3, 1
    s_cselect_b64 vcc, -1, 0
    s_bitcmp1_b32 s3, 0
    s_waitcnt vmcnt(6)
    s_cbranch_vccnz L_hi72
    s_waitcnt vmcnt(4)
    s_cbranch_scc1 L_go72
    s_waitcnt vmcnt(3)
L_hi72:
    s_cbranch_scc1 L_go72
    s_waitcnt vmcnt(5)
L_go72:
    buffer_load_dwordx4 v[76:79], v12, s[32:35], s84 offen offset:0 nt
    s_bitcmp1_b32 s3, 0
    s_waitcnt vmcnt(6)
    s_cbranch_vccnz L_hi73
    s_waitcnt vmcnt(4)
    s_cbranch_scc1 L_go73
    s_waitcnt vmcnt(3)
L_hi73:
    s_cbranch_scc1 L_go73
    s_waitcnt vmcnt(5)
L_go73:
    buffer_load_dwordx4 v[80:83], v12, s[32:35], s84 offen offset:128 nt
    s_bitcmp1_b32 s3, 0
    s_waitcnt vmcnt(6)
    s_cbranch_vccnz L_hi74
    s_waitcnt vmcnt(4)
    s_cbranch_scc1 L_go74
    s_waitcnt vmcnt(3)
L_hi74:
    s_cbranch_scc1 L_go74
    s_waitcnt vmcnt(5)
L_go74:
    buffer_load_dwordx4 v[84:87], v12, s[32:35], s84 offen offset:256 nt
    v_mov_b32 v13, 0
    v_mov_b32 v14, 1
    ds_max_u32 v13, v14 offset:10796
    v_dot2_f32_bf16 v52, v112, v16, 0
    v_dot2_f32_bf16 v13, v116, v20, 0
    v_dot2_f32_bf16 v14, v120, v24, 0
    v_dot2_f32_bf16 v52, v113, v17, v52
    v_dot2_f32_bf16 v13, v117, v21, v13
    v_dot2_f32_bf16 v14, v121, v25, v14
    v_dot2_f32_bf16 v52, v114, v18, v52
    v_dot2_f32_bf16 v13, v118, v22, v13
    v_dot2_f32_bf16 v14, v122, v26, v14
    v_dot2_f32_bf16 v52, v115, v19, v52
    v_dot2_f32_bf16 v13, v119, v23, v13
    v_dot2_f32_bf16 v14, v123, v27, v14
    s_nop 2
    v_add_f32 v13, v13, v14
    v_add_f32 v52, v52, v13
    s_nop 1
    v_add_f32_dpp v52, v52, v52 quad_perm:[1,0,3,2] row_mask:0xf bank_mask:0xf
    s_nop 1
    v_add_f32_dpp v52, v52, v52 quad_perm:[2,3,0,1] row_mask:0xf bank_mask:0xf
    s_nop 1
    v_add_f32_dpp v52, v52, v52 row_half_mirror row_mask:0xf bank_mask:0xf
    v_cvt_pk_bf16_f32 v52, 0, v52
    v_mul_f32 v52, 0x3d93cd3a, v52
    v_cvt_pk_bf16_f32 v52, 0, v52
    v_dot2_f32_bf16 v53, v124, v16, 0
    v_dot2_f32_bf16 v13, v128, v20, 0
    v_dot2_f32_bf16 v14, v132, v24, 0
    v_dot2_f32_bf16 v53, v125, v17, v53
    v_dot2_f32_bf16 v13, v129, v21, v13
    v_dot2_f32_bf16 v14, v133, v25, v14
    v_dot2_f32_bf16 v53, v126, v18, v53
    v_dot2_f32_bf16 v13, v130, v22, v13
    v_dot2_f32_bf16 v14, v134, v26, v14
    v_dot2_f32_bf16 v53, v127, v19, v53
    v_dot2_f32_bf16 v13, v131, v23, v13
    v_dot2_f32_bf16 v14, v135, v27, v14
    s_nop 2
    v_add_f32 v13, v13, v14
    v_add_f32 v53, v53, v13
    s_nop 1
    v_add_f32_dpp v53, v53, v53 quad_perm:[1,0,3,2] row_mask:0xf bank_mask:0xf
    s_nop 1
    v_add_f32_dpp v53, v53, v53 quad_perm:[2,3,0,1] row_mask:0xf bank_mask:0xf
    s_nop 1
    v_add_f32_dpp v53, v53, v53 row_half_mirror row_mask:0xf bank_mask:0xf
    v_cvt_pk_bf16_f32 v53, 0, v53
    v_mul_f32 v53, 0x3d93cd3a, v53
    v_cvt_pk_bf16_f32 v53, 0, v53
    v_max3_f32 v15, v15, v52, v53
    s_addk_i32 s84, 3072
    s_cmp_eq_u32 s84, s34
    s_cselect_b32 s84, 0, s84
    s_sub_u32 s83, s83, 1
    s_cselect_b32 s83, 0, s83
    s_cselect_b32 s3, s31, s2
    s_bitcmp1_b32 s3, 1
    s_cselect_b64 vcc, -1, 0
    s_bitcmp1_b32 s3, 0
    s_waitcnt vmcnt(6)
    s_cbranch_vccnz L_hi75
    s_waitcnt vmcnt(4)
    s_cbranch_scc1 L_go75
    s_waitcnt vmcnt(3)
L_hi75:
    s_cbranch_scc1 L_go75
    s_waitcnt vmcnt(5)
L_go75:
    buffer_load_dwordx4 v[88:91], v12, s[32:35], s84 offen offset:0 nt
    s_bitcmp1_b32 s3, 0
    s_waitcnt vmcnt(6)
    s_cbranch_vccnz L_hi76
    s_waitcnt vmcnt(4)
    s_cbranch_scc1 L_go76
    s_waitcnt vmcnt(3)
L_hi76:
    s_cbranch_scc1 L_go76
    s_waitcnt vmcnt(5)
L_go76:
    buffer_load_dwordx4 v[92:95], v12, s[32:35], s84 offen offset:128 nt
    s_bitcmp1_b32 s3, 0
    s_waitcnt vmcnt(6)
    s_cbranch_vccnz L_hi77
    s_waitcnt vmcnt(4)
    s_cbranch_scc1 L_go77
    s_waitcnt vmcnt(3)
L_hi77:
    s_cbranch_scc1 L_go77
    s_waitcnt vmcnt(5)
L_go77:
    buffer_load_dwordx4 v[96:99], v12, s[32:35], s84 offen offset:256 nt
    v_dot2_f32_bf16 v54, v136, v16, 0
    v_dot2_f32_bf16 v13, v140, v20, 0
    v_dot2_f32_bf16 v14, v144, v24, 0
    v_dot2_f32_bf16 v54, v137, v17, v54
    v_dot2_f32_bf16 v13, v141, v21, v13
    v_dot2_f32_bf16 v14, v145, v25, v14
    v_dot2_f32_bf16 v54, v138, v18, v54
    v_dot2_f32_bf16 v13, v142, v22, v13
    v_dot2_f32_bf16 v14, v146, v26, v14
    v_dot2_f32_bf16 v54, v139, v19, v54
    v_dot2_f32_bf16 v13, v143, v23, v13
    v_dot2_f32_bf16 v14, v147, v27, v14
    s_nop 2
    v_add_f32 v13, v13, v14
    v_add_f32 v54, v54, v13
    s_nop 1
    v_add_f32_dpp v54, v54, v54 quad_perm:[1,0,3,2] row_mask:0xf bank_mask:0xf
    s_nop 1
    v_add_f32_dpp v54, v54, v54 quad_perm:[2,3,0,1] row_mask:0xf bank_mask:0xf
    s_nop 1
    v_add_f32_dpp v54, v54, v54 row_half_mirror row_mask:0xf bank_mask:0xf
    v_cvt_pk_bf16_f32 v54, 0, v54
    v_mul_f32 v54, 0x3d93cd3a, v54
    v_cvt_pk_bf16_f32 v54, 0, v54
    v_dot2_f32_bf16 v55, v148, v16, 0
    v_dot2_f32_bf16 v13, v152, v20, 0
    v_dot2_f32_bf16 v14, v156, v24, 0
    v_dot2_f32_bf16 v55, v149, v17, v55
    v_dot2_f32_bf16 v13, v153, v21, v13
    v_dot2_f32_bf16 v14, v157, v25, v14
    v_dot2_f32_bf16 v55, v150, v18, v55
    v_dot2_f32_bf16 v13, v154, v22, v13
    v_dot2_f32_bf16 v14, v158, v26, v14
    v_dot2_f32_bf16 v55, v151, v19, v55
    v_dot2_f32_bf16 v13, v155, v23, v13
    v_dot2_f32_bf16 v14, v159, v27, v14
    s_nop 2
    v_add_f32 v13, v13, v14
    v_add_f32 v55, v55, v13
    s_nop 1
    v_add_f32_dpp v55, v55, v55 quad_perm:[1,0,3,2] row_mask:0xf bank_mask:0xf
    s_nop 1
    v_add_f32_dpp v55, v55, v55 quad_perm:[2,3,0,1] row_mask:0xf bank_mask:0xf
    s_nop 1
    v_add_f32_dpp v55, v55, v55 row_half_mirror row_mask:0xf bank_mask:0xf
    v_cvt_pk_bf16_f32 v55, 0, v55
    v_mul_f32 v55, 0x3d93cd3a, v55
    v_cvt_pk_bf16_f32 v55, 0, v55
    v_max3_f32 v15, v15, v54, v55
    s_addk_i32 s84, 3072
    s_cmp_eq_u32 s84, s34
    s_cselect_b32 s84, 0, s84
    s_sub_u32 s83, s83, 1
    s_cselect_b32 s83, 0, s83
    s_cselect_b32 s3, s31, s2
    s_bitcmp1_b32 s3, 1
    s_cselect_b64 vcc, -1, 0
    s_bitcmp1_b32 s3, 0
    s_waitcnt vmcnt(6)
    s_cbranch_vccnz L_hi78
    s_waitcnt vmcnt(4)
    s_cbranch_scc1 L_go78
    s_waitcnt vmcnt(3)
L_hi78:
    s_cbranch_scc1 L_go78
    s_waitcnt vmcnt(5)
L_go78:
    buffer_load_dwordx4 v[100:103], v12, s[32:35], s84 offen offset:0 nt
    s_bitcmp1_b32 s3, 0
    s_waitcnt vmcnt(6)
    s_cbranch_vccnz L_hi79
    s_waitcnt vmcnt(4)
    s_cbranch_scc1 L_go79
    s_waitcnt vmcnt(3)
L_hi79:
    s_cbranch_scc1 L_go79
    s_waitcnt vmcnt(5)
L_go79:
    buffer_load_dwordx4 v[104:107], v12, s[32:35], s84 offen offset:128 nt
    s_bitcmp1_b32 s3, 0
    s_waitcnt vmcnt(6)
    s_cbranch_vccnz L_hi80
    s_waitcnt vmcnt(4)
    s_cbranch_scc1 L_go80
    s_waitcnt vmcnt(3)
L_hi80:
    s_cbranch_scc1 L_go80
    s_waitcnt vmcnt(5)
L_go80:
    buffer_load_dwordx4 v[108:111], v12, s[32:35], s84 offen offset:256 nt
    v_dot2_f32_bf16 v56, v64, v16, 0
    v_dot2_f32_bf16 v13, v68, v20, 0
    v_dot2_f32_bf16 v14, v72, v24, 0
    v_dot2_f32_bf16 v56, v65, v17, v56
    v_dot2_f32_bf16 v13, v69, v21, v13
    v_dot2_f32_bf16 v14, v73, v25, v14
    v_dot2_f32_bf16 v56, v66, v18, v56
    v_dot2_f32_bf16 v13, v70, v22, v13
    v_dot2_f32_bf16 v14, v74, v26, v14
    v_dot2_f32_bf16 v56, v67, v19, v56
    v_dot2_f32_bf16 v13, v71, v23, v13
    v_dot2_f32_bf16 v14, v75, v27, v14
    s_nop 2
    v_add_f32 v13, v13, v14
    v_add_f32 v56, v56, v13
    s_nop 1
    v_add_f32_dpp v56, v56, v56 quad_perm:[1,0,3,2] row_mask:0xf bank_mask:0xf
    s_nop 1
    v_add_f32_dpp v56, v56, v56 quad_perm:[2,3,0,1] row_mask:0xf bank_mask:0xf
    s_nop 1
    v_add_f32_dpp v56, v56, v56 row_half_mirror row_mask:0xf bank_mask:0xf
    v_cvt_pk_bf16_f32 v56, 0, v56
    v_mul_f32 v56, 0x3d93cd3a, v56
    v_cvt_pk_bf16_f32 v56, 0, v56
    s_addk_i32 s84, 3072
    s_cmp_eq_u32 s84, s34
    s_cselect_b32 s84, 0, s84
    s_sub_u32 s83, s83, 1
    s_cselect_b32 s83, 0, s83
    s_cselect_b32 s3, s31, s2
    s_bitcmp1_b32 s3, 1
    s_cselect_b64 vcc, -1, 0
    s_bitcmp1_b32 s3, 0
    s_waitcnt vmcnt(6)
    s_cbranch_vccnz L_hi81
    s_waitcnt vmcnt(4)
    s_cbranch_scc1 L_go81
    s_waitcnt vmcnt(3)
L_hi81:
    s_cbranch_scc1 L_go81
    s_waitcnt vmcnt(5)
L_go81:
    buffer_load_dwordx4 v[64:67], v12, s[32:35], s84 offen offset:0 nt
    s_bitcmp1_b32 s3, 0
    s_waitcnt vmcnt(6)
    s_cbranch_vccnz L_hi82
    s_waitcnt vmcnt(4)
    s_cbranch_scc1 L_go82
    s_waitcnt vmcnt(3)
L_hi82:
    s_cbranch_scc1 L_go82
    s_waitcnt vmcnt(5)
L_go82:
    buffer_load_dwordx4 v[68:71], v12, s[32:35], s84 offen offset:128 nt
    s_bitcmp1_b32 s3, 0
    s_waitcnt vmcnt(6)
    s_cbranch_vccnz L_hi83
    s_waitcnt vmcnt(4)
    s_cbranch_scc1 L_go83
    s_waitcnt vmcnt(3)
L_hi83:
    s_cbranch_scc1 L_go83
    s_waitcnt vmcnt(5)
L_go83:
    buffer_load_dwordx4 v[72:75], v12, s[32:35], s84 offen offset:256 nt
    v_mov_b32 v13, 0
    ds_read_b32 v13, v13 offset:10824
    s_waitcnt lgkmcnt(0)
    v_readfirstlane_b32 s63, v13
    s_cmp_eq_u32 s63, 0
    s_cselect_b32 s63, 16, s63
    s_cmp_eq_u32 s26, 0
    s_cselect_b32 s64, 4, 0
    s_sub_i32 s63, s63, s64
    s_sub_i32 s64, 16, s63
    s_max_i32 s64, s64, 0
    s_sub_i32 s65, s63, 20
    s_max_i32 s65, s65, 0
    s_cmp_lg_u32 s65, 0
    s_cselect_b32 s66, 1, -1
    s_add_i32 s2, s31, s66
    s_min_u32 s2, s2, 3
    s_add_u32 s64, s64, s65
    s_mul_i32 s83, s64, 2
    s_lshr_b32 s83, s83, 2
    v_dot2_f32_bf16 v57, v76, v16, 0
    v_dot2_f32_bf16 v13, v80, v20, 0
    v_dot2_f32_bf16 v14, v84, v24, 0
    v_dot2_f32_bf16 v57, v77, v17, v57
    v_dot2_f32_bf16 v13, v81, v21, v13
    v_dot2_f32_bf16 v14, v85, v25, v14
    v_dot2_f32_bf16 v57, v78, v18, v57
    v_dot2_f32_bf16 v13, v82, v22, v13
    v_dot2_f32_bf16 v14, v86, v26, v14
    v_dot2_f32_bf16 v57, v79, v19, v57
    v_dot2_f32_bf16 v13, v83, v23, v13
    v_dot2_f32_bf16 v14, v87, v27, v14
    s_nop 2
    v_add_f32 v13, v13, v14
    v_add_f32 v57, v57, v13
    s_nop 1
    v_add_f32_dpp v57, v57, v57 quad_perm:[1,0,3,2] row_mask:0xf bank_mask:0xf
    s_nop 1
    v_add_f32_dpp v57, v57, v57 quad_perm:[2,3,0,1] row_mask:0xf bank_mask:0xf
    s_nop 1
    v_add_f32_dpp v57, v57, v57 row_half_mirror row_mask:0xf bank_mask:0xf
    v_cvt_pk_bf16_f32 v57, 0, v57
    v_mul_f32 v57, 0x3d93cd3a, v57
    v_cvt_pk_bf16_f32 v57, 0, v57
    v_max3_f32 v15, v15, v56, v57
    s_addk_i32 s84, 3072
    s_cmp_eq_u32 s84, s34
    s_cselect_b32 s84, 0, s84
    s_sub_u32 s83, s83, 1
    s_cselect_b32 s83, 0, s83
    s_cselect_b32 s3, s31, s2
    s_bitcmp1_b32 s3, 1
    s_cselect_b64 vcc, -1, 0
    s_bitcmp1_b32 s3, 0
    s_waitcnt vmcnt(6)
    s_cbranch_vccnz L_hi84
    s_waitcnt vmcnt(4)
    s_cbranch_scc1 L_go84
    s_waitcnt vmcnt(3)
L_hi84:
    s_cbranch_scc1 L_go84
    s_waitcnt vmcnt(5)
L_go84:
    buffer_load_dwordx4 v[76:79], v12, s[32:35], s84 offen offset:0 nt
    s_bitcmp1_b32 s3, 0
    s_waitcnt vmcnt(6)
    s_cbranch_vccnz L_hi85
    s_waitcnt vmcnt(4)
    s_cbranch_scc1 L_go85
    s_waitcnt vmcnt(3)
L_hi85:
    s_cbranch_scc1 L_go85
    s_waitcnt vmcnt(5)
L_go85:
    buffer_load_dwordx4 v[80:83], v12, s[32:35], s84 offen offset:128 nt
    s_bitcmp1_b32 s3, 0
    s_waitcnt vmcnt(6)
    s_cbranch_vccnz L_hi86
    s_waitcnt vmcnt(4)
    s_cbranch_scc1 L_go86
    s_waitcnt vmcnt(3)
L_hi86:
    s_cbranch_scc1 L_go86
    s_waitcnt vmcnt(5)
L_go86:
    buffer_load_dwordx4 v[84:87], v12, s[32:35], s84 offen offset:256 nt
    v_dot2_f32_bf16 v58, v88, v16, 0
    v_dot2_f32_bf16 v13, v92, v20, 0
    v_dot2_f32_bf16 v14, v96, v24, 0
    v_dot2_f32_bf16 v58, v89, v17, v58
    v_dot2_f32_bf16 v13, v93, v21, v13
    v_dot2_f32_bf16 v14, v97, v25, v14
    v_dot2_f32_bf16 v58, v90, v18, v58
    v_dot2_f32_bf16 v13, v94, v22, v13
    v_dot2_f32_bf16 v14, v98, v26, v14
    v_dot2_f32_bf16 v58, v91, v19, v58
    v_dot2_f32_bf16 v13, v95, v23, v13
    v_dot2_f32_bf16 v14, v99, v27, v14
    s_nop 2
    v_add_f32 v13, v13, v14
    v_add_f32 v58, v58, v13
    s_nop 1
    v_add_f32_dpp v58, v58, v58 quad_perm:[1,0,3,2] row_mask:0xf bank_mask:0xf
    s_nop 1
    v_add_f32_dpp v58, v58, v58 quad_perm:[2,3,0,1] row_mask:0xf bank_mask:0xf
    s_nop 1
    v_add_f32_dpp v58, v58, v58 row_half_mirror row_mask:0xf bank_mask:0xf
    v_cvt_pk_bf16_f32 v58, 0, v58
    v_mul_f32 v58, 0x3d93cd3a, v58
    v_cvt_pk_bf16_f32 v58, 0, v58
    s_addk_i32 s84, 3072
    s_cmp_eq_u32 s84, s34
    s_cselect_b32 s84, 0, s84
    s_sub_u32 s83, s83, 1
    s_cselect_b32 s83, 0, s83
    s_cselect_b32 s3, s31, s2
    s_bitcmp1_b32 s3, 1
    s_cselect_b64 vcc, -1, 0
    s_bitcmp1_b32 s3, 0
    s_waitcnt vmcnt(6)
    s_cbranch_vccnz L_hi87
    s_waitcnt vmcnt(4)
    s_cbranch_scc1 L_go87
    s_waitcnt vmcnt(3)
L_hi87:
    s_cbranch_scc1 L_go87
    s_waitcnt vmcnt(5)
L_go87:
    buffer_load_dwordx4 v[88:91], v12, s[32:35], s84 offen offset:0 nt
    s_bitcmp1_b32 s3, 0
    s_waitcnt vmcnt(6)
    s_cbranch_vccnz L_hi88
    s_waitcnt vmcnt(4)
    s_cbranch_scc1 L_go88
    s_waitcnt vmcnt(3)
L_hi88:
    s_cbranch_scc1 L_go88
    s_waitcnt vmcnt(5)
L_go88:
    buffer_load_dwordx4 v[92:95], v12, s[32:35], s84 offen offset:128 nt
    s_bitcmp1_b32 s3, 0
    s_waitcnt vmcnt(6)
    s_cbranch_vccnz L_hi89
    s_waitcnt vmcnt(4)
    s_cbranch_scc1 L_go89
    s_waitcnt vmcnt(3)
L_hi89:
    s_cbranch_scc1 L_go89
    s_waitcnt vmcnt(5)
L_go89:
    buffer_load_dwordx4 v[96:99], v12, s[32:35], s84 offen offset:256 nt
    v_dot2_f32_bf16 v59, v100, v16, 0
    v_dot2_f32_bf16 v13, v104, v20, 0
    v_dot2_f32_bf16 v14, v108, v24, 0
    v_dot2_f32_bf16 v59, v101, v17, v59
    v_dot2_f32_bf16 v13, v105, v21, v13
    v_dot2_f32_bf16 v14, v109, v25, v14
    v_dot2_f32_bf16 v59, v102, v18, v59
    v_dot2_f32_bf16 v13, v106, v22, v13
    v_dot2_f32_bf16 v14, v110, v26, v14
    v_dot2_f32_bf16 v59, v103, v19, v59
    v_dot2_f32_bf16 v13, v107, v23, v13
    v_dot2_f32_bf16 v14, v111, v27, v14
    s_nop 2
    v_add_f32 v13, v13, v14
    v_add_f32 v59, v59, v13
    s_nop 1
    v_add_f32_dpp v59, v59, v59 quad_perm:[1,0,3,2] row_mask:0xf bank_mask:0xf
    s_nop 1
    v_add_f32_dpp v59, v59, v59 quad_perm:[2,3,0,1] row_mask:0xf bank_mask:0xf
    s_nop 1
    v_add_f32_dpp v59, v59, v59 row_half_mirror row_mask:0xf bank_mask:0xf
    v_cvt_pk_bf16_f32 v59, 0, v59
    v_mul_f32 v59, 0x3d93cd3a, v59
    v_cvt_pk_bf16_f32 v59, 0, v59
    v_max3_f32 v15, v15, v58, v59
    s_addk_i32 s84, 3072
    s_cmp_eq_u32 s84, s34
    s_cselect_b32 s84, 0, s84
    s_sub_u32 s83, s83, 1
    s_cselect_b32 s83, 0, s83
    s_cselect_b32 s3, s31, s2
    s_bitcmp1_b32 s3, 1
    s_cselect_b64 vcc, -1, 0
    s_bitcmp1_b32 s3, 0
    s_waitcnt vmcnt(6)
    s_cbranch_vccnz L_hi90
    s_waitcnt vmcnt(4)
    s_cbranch_scc1 L_go90
    s_waitcnt vmcnt(3)
L_hi90:
    s_cbranch_scc1 L_go90
    s_waitcnt vmcnt(5)
L_go90:
    buffer_load_dwordx4 v[100:103], v12, s[32:35], s84 offen offset:0 nt
    s_bitcmp1_b32 s3, 0
    s_waitcnt vmcnt(6)
    s_cbranch_vccnz L_hi91
    s_waitcnt vmcnt(4)
    s_cbranch_scc1 L_go91
    s_waitcnt vmcnt(3)
L_hi91:
    s_cbranch_scc1 L_go91
    s_waitcnt vmcnt(5)
L_go91:
    buffer_load_dwordx4 v[104:107], v12, s[32:35], s84 offen offset:128 nt
    s_bitcmp1_b32 s3, 0
    s_waitcnt vmcnt(6)
    s_cbranch_vccnz L_hi92
    s_waitcnt vmcnt(4)
    s_cbranch_scc1 L_go92
    s_waitcnt vmcnt(3)
L_hi92:
    s_cbranch_scc1 L_go92
    s_waitcnt vmcnt(5)
L_go92:
    buffer_load_dwordx4 v[108:111], v12, s[32:35], s84 offen offset:256 nt
    v_dot2_f32_bf16 v60, v64, v16, 0
    v_dot2_f32_bf16 v13, v68, v20, 0
    v_dot2_f32_bf16 v14, v72, v24, 0
    v_dot2_f32_bf16 v60, v65, v17, v60
    v_dot2_f32_bf16 v13, v69, v21, v13
    v_dot2_f32_bf16 v14, v73, v25, v14
    v_dot2_f32_bf16 v60, v66, v18, v60
    v_dot2_f32_bf16 v13, v70, v22, v13
    v_dot2_f32_bf16 v14, v74, v26, v14
    v_dot2_f32_bf16 v60, v67, v19, v60
    v_dot2_f32_bf16 v13, v71, v23, v13
    v_dot2_f32_bf16 v14, v75, v27, v14
    s_nop 2
    v_add_f32 v13, v13, v14
    v_add_f32 v60, v60, v13
    s_nop 1
    v_add_f32_dpp v60, v60, v60 quad_perm:[1,0,3,2] row_mask:0xf bank_mask:0xf
    s_nop 1
    v_add_f32_dpp v60, v60, v60 quad_perm:[2,3,0,1] row_mask:0xf bank_mask:0xf
    s_nop 1
    v_add_f32_dpp v60, v60, v60 row_half_mirror row_mask:0xf bank_mask:0xf
    v_cvt_pk_bf16_f32 v60, 0, v60
    v_mul_f32 v60, 0x3d93cd3a, v60
    v_cvt_pk_bf16_f32 v60, 0, v60
    s_addk_i32 s84, 3072
    s_cmp_eq_u32 s84, s34
    s_cselect_b32 s84, 0, s84
    s_sub_u32 s83, s83, 1
    s_cselect_b32 s83, 0, s83
    s_cselect_b32 s3, s31, s2
    s_bitcmp1_b32 s3, 1
    s_cselect_b64 vcc, -1, 0
    s_bitcmp1_b32 s3, 0
    s_waitcnt vmcnt(6)
    s_cbranch_vccnz L_hi93
    s_waitcnt vmcnt(4)
    s_cbranch_scc1 L_go93
    s_waitcnt vmcnt(3)
L_hi93:
    s_cbranch_scc1 L_go93
    s_waitcnt vmcnt(5)
L_go93:
    buffer_load_dwordx4 v[64:67], v12, s[36:39], s84 offen offset:0 nt
    s_bitcmp1_b32 s3, 0
    s_waitcnt vmcnt(6)
    s_cbranch_vccnz L_hi94
    s_waitcnt vmcnt(4)
    s_cbranch_scc1 L_go94
    s_waitcnt vmcnt(3)
L_hi94:
    s_cbranch_scc1 L_go94
    s_waitcnt vmcnt(5)
L_go94:
    buffer_load_dwordx4 v[68:71], v12, s[36:39], s84 offen offset:128 nt
    s_bitcmp1_b32 s3, 0
    s_waitcnt vmcnt(6)
    s_cbranch_vccnz L_hi95
    s_waitcnt vmcnt(4)
    s_cbranch_scc1 L_go95
    s_waitcnt vmcnt(3)
L_hi95:
    s_cbranch_scc1 L_go95
    s_waitcnt vmcnt(5)
L_go95:
    buffer_load_dwordx4 v[72:75], v12, s[36:39], s84 offen offset:256 nt
    v_dot2_f32_bf16 v61, v76, v16, 0
    v_dot2_f32_bf16 v13, v80, v20, 0
    v_dot2_f32_bf16 v14, v84, v24, 0
    v_dot2_f32_bf16 v61, v77, v17, v61
    v_dot2_f32_bf16 v13, v81, v21, v13
    v_dot2_f32_bf16 v14, v85, v25, v14
    v_dot2_f32_bf16 v61, v78, v18, v61
    v_dot2_f32_bf16 v13, v82, v22, v13
    v_dot2_f32_bf16 v14, v86, v26, v14
    v_dot2_f32_bf16 v61, v79, v19, v61
    v_dot2_f32_bf16 v13, v83, v23, v13
    v_dot2_f32_bf16 v14, v87, v27, v14
    s_nop 2
    v_add_f32 v13, v13, v14
    v_add_f32 v61, v61, v13
    s_nop 1
    v_add_f32_dpp v61, v61, v61 quad_perm:[1,0,3,2] row_mask:0xf bank_mask:0xf
    s_nop 1
    v_add_f32_dpp v61, v61, v61 quad_perm:[2,3,0,1] row_mask:0xf bank_mask:0xf
    s_nop 1
    v_add_f32_dpp v61, v61, v61 row_half_mirror row_mask:0xf bank_mask:0xf
    v_cvt_pk_bf16_f32 v61, 0, v61
    v_mul_f32 v61, 0x3d93cd3a, v61
    v_cvt_pk_bf16_f32 v61, 0, v61
    v_max3_f32 v15, v15, v60, v61
    s_addk_i32 s84, 3072
    s_cmp_eq_u32 s84, s34
    s_cselect_b32 s84, 0, s84
    s_sub_u32 s83, s83, 1
    s_cselect_b32 s83, 0, s83
    s_cselect_b32 s3, s31, s2
    s_bitcmp1_b32 s3, 1
    s_cselect_b64 vcc, -1, 0
    s_bitcmp1_b32 s3, 0
    s_waitcnt vmcnt(6)
    s_cbranch_vccnz L_hi96
    s_waitcnt vmcnt(4)
    s_cbranch_scc1 L_go96
    s_waitcnt vmcnt(3)
L_hi96:
    s_cbranch_scc1 L_go96
    s_waitcnt vmcnt(5)
L_go96:
    buffer_load_dwordx4 v[76:79], v12, s[36:39], s84 offen offset:0 nt
    s_bitcmp1_b32 s3, 0
    s_waitcnt vmcnt(6)
    s_cbranch_vccnz L_hi97
    s_waitcnt vmcnt(4)
    s_cbranch_scc1 L_go97
    s_waitcnt vmcnt(3)
L_hi97:
    s_cbranch_scc1 L_go97
    s_waitcnt vmcnt(5)
L_go97:
    buffer_load_dwordx4 v[80:83], v12, s[36:39], s84 offen offset:128 nt
    s_bitcmp1_b32 s3, 0
    s_waitcnt vmcnt(6)
    s_cbranch_vccnz L_hi98
    s_waitcnt vmcnt(4)
    s_cbranch_scc1 L_go98
    s_waitcnt vmcnt(3)
L_hi98:
    s_cbranch_scc1 L_go98
    s_waitcnt vmcnt(5)
L_go98:
    buffer_load_dwordx4 v[84:87], v12, s[36:39], s84 offen offset:256 nt
    v_dot2_f32_bf16 v62, v88, v16, 0
    v_dot2_f32_bf16 v13, v92, v20, 0
    v_dot2_f32_bf16 v14, v96, v24, 0
    v_dot2_f32_bf16 v62, v89, v17, v62
    v_dot2_f32_bf16 v13, v93, v21, v13
    v_dot2_f32_bf16 v14, v97, v25, v14
    v_dot2_f32_bf16 v62, v90, v18, v62
    v_dot2_f32_bf16 v13, v94, v22, v13
    v_dot2_f32_bf16 v14, v98, v26, v14
    v_dot2_f32_bf16 v62, v91, v19, v62
    v_dot2_f32_bf16 v13, v95, v23, v13
    v_dot2_f32_bf16 v14, v99, v27, v14
    s_nop 2
    v_add_f32 v13, v13, v14
    v_add_f32 v62, v62, v13
    s_nop 1
    v_add_f32_dpp v62, v62, v62 quad_perm:[1,0,3,2] row_mask:0xf bank_mask:0xf
    s_nop 1
    v_add_f32_dpp v62, v62, v62 quad_perm:[2,3,0,1] row_mask:0xf bank_mask:0xf
    s_nop 1
    v_add_f32_dpp v62, v62, v62 row_half_mirror row_mask:0xf bank_mask:0xf
    v_cvt_pk_bf16_f32 v62, 0, v62
    v_mul_f32 v62, 0x3d93cd3a, v62
    v_cvt_pk_bf16_f32 v62, 0, v62
    s_addk_i32 s84, 3072
    s_cmp_eq_u32 s84, s34
    s_cselect_b32 s84, 0, s84
    s_sub_u32 s83, s83, 1
    s_cselect_b32 s83, 0, s83
    s_cselect_b32 s3, s31, s2
    s_bitcmp1_b32 s3, 1
    s_cselect_b64 vcc, -1, 0
    s_bitcmp1_b32 s3, 0
    s_waitcnt vmcnt(6)
    s_cbranch_vccnz L_hi99
    s_waitcnt vmcnt(4)
    s_cbranch_scc1 L_go99
    s_waitcnt vmcnt(3)
L_hi99:
    s_cbranch_scc1 L_go99
    s_waitcnt vmcnt(5)
L_go99:
    buffer_load_dwordx4 v[88:91], v12, s[36:39], s84 offen offset:0 nt
    s_bitcmp1_b32 s3, 0
    s_waitcnt vmcnt(6)
    s_cbranch_vccnz L_hi100
    s_waitcnt vmcnt(4)
    s_cbranch_scc1 L_go100
    s_waitcnt vmcnt(3)
L_hi100:
    s_cbranch_scc1 L_go100
    s_waitcnt vmcnt(5)
L_go100:
    buffer_load_dwordx4 v[92:95], v12, s[36:39], s84 offen offset:128 nt
    s_bitcmp1_b32 s3, 0
    s_waitcnt vmcnt(6)
    s_cbranch_vccnz L_hi101
    s_waitcnt vmcnt(4)
    s_cbranch_scc1 L_go101
    s_waitcnt vmcnt(3)
L_hi101:
    s_cbranch_scc1 L_go101
    s_waitcnt vmcnt(5)
L_go101:
    buffer_load_dwordx4 v[96:99], v12, s[36:39], s84 offen offset:256 nt
    v_dot2_f32_bf16 v63, v100, v16, 0
    v_dot2_f32_bf16 v13, v104, v20, 0
    v_dot2_f32_bf16 v14, v108, v24, 0
    v_dot2_f32_bf16 v63, v101, v17, v63
    v_dot2_f32_bf16 v13, v105, v21, v13
    v_dot2_f32_bf16 v14, v109, v25, v14
    v_dot2_f32_bf16 v63, v102, v18, v63
    v_dot2_f32_bf16 v13, v106, v22, v13
    v_dot2_f32_bf16 v14, v110, v26, v14
    v_dot2_f32_bf16 v63, v103, v19, v63
    v_dot2_f32_bf16 v13, v107, v23, v13
    v_dot2_f32_bf16 v14, v111, v27, v14
    s_nop 2
    v_add_f32 v13, v13, v14
    v_add_f32 v63, v63, v13
    s_nop 1
    v_add_f32_dpp v63, v63, v63 quad_perm:[1,0,3,2] row_mask:0xf bank_mask:0xf
    s_nop 1
    v_add_f32_dpp v63, v63, v63 quad_perm:[2,3,0,1] row_mask:0xf bank_mask:0xf
    s_nop 1
    v_add_f32_dpp v63, v63, v63 row_half_mirror row_mask:0xf bank_mask:0xf
    v_cvt_pk_bf16_f32 v63, 0, v63
    v_mul_f32 v63, 0x3d93cd3a, v63
    v_cvt_pk_bf16_f32 v63, 0, v63
    v_max3_f32 v15, v15, v62, v63
    s_nop 1
    v_max_f32_dpp v15, v15, v15 row_ror:8 row_mask:0xf bank_mask:0xf
    v_mov_b32 v13, v15
    s_nop 1
    v_permlane16_swap_b32 v15, v13
    v_max_f32 v15, v15, v13
    v_mov_b32 v13, v15
    s_nop 1
    v_permlane32_swap_b32 v15, v13
    v_max_f32 v15, v15, v13
    s_lshl_b32 s60, s30, 2
    v_mov_b32 v14, s60
    s_mov_b64 exec, 1
    ds_write_b32 v14, v15 offset:10752
    s_mov_b64 exec, -1
    s_addk_i32 s84, 3072
    s_cmp_eq_u32 s84, s34
    s_cselect_b32 s84, 0, s84
    s_sub_u32 s83, s83, 1
    s_cselect_b32 s83, 0, s83
    s_cselect_b32 s3, s31, s2
    s_bitcmp1_b32 s3, 1
    s_cselect_b64 vcc, -1, 0
    buffer_load_dwordx4 v[100:103], v12, s[36:39], s84 offen offset:0 nt
    buffer_load_dwordx4 v[104:107], v12, s[36:39], s84 offen offset:128 nt
    buffer_load_dwordx4 v[108:111], v12, s[36:39], s84 offen offset:256 nt
    s_addk_i32 s84, 3072
    s_cmp_eq_u32 s84, s34
    s_cselect_b32 s84, 0, s84
    s_sub_u32 s83, s83, 1
    s_cselect_b32 s83, 0, s83
    s_cselect_b32 s3, s31, s2
    s_bitcmp1_b32 s3, 1
    s_cselect_b64 vcc, -1, 0
    buffer_load_dwordx4 v[112:115], v12, s[36:39], s84 offen offset:0 nt
    buffer_load_dwordx4 v[116:119], v12, s[36:39], s84 offen offset:128 nt
    buffer_load_dwordx4 v[120:123], v12, s[36:39], s84 offen offset:256 nt
    s_waitcnt lgkmcnt(0)
    s_barrier
    v_mov_b32 v13, 0
    ds_read_b128 v[8:11], v13 offset:10752
    ds_read_b32 v16, v13 offset:10784
    s_lshl_b32 s60, s30, 10
    s_add_u32 s60, s60, 40672
    v_add_u32 v4, s60, v3
    v_add_u32 v5, 0x10000, v4
    ds_read_b128 v[176:179], v4 offset:0
    ds_read_b128 v[180:183], v4 offset:8192
    ds_read_b128 v[184:187], v4 offset:16384
    ds_read_b128 v[188:191], v4 offset:24576
    ds_read_b128 v[192:195], v4 offset:32768
    ds_read_b128 v[196:199], v4 offset:40960
    ds_read_b128 v[200:203], v4 offset:49152
    ds_read_b128 v[204:207], v4 offset:57344
    ds_read_b128 v[208:211], v5 offset:0
    ds_read_b128 v[212:215], v5 offset:8192
    s_waitcnt lgkmcnt(10)
    v_readfirstlane_b32 s82, v16
    v_max3_f32 v15, v8, v9, v10
    v_max_f32 v15, v15, v11
    v_sub_f32 v32, v32, v15
    v_mul_f32 v32, 0x3fb8aa3b, v32
    v_exp_f32 v32, v32
    v_sub_f32 v33, v33, v15
    v_mul_f32 v33, 0x3fb8aa3b, v33
    v_exp_f32 v33, v33
    v_sub_f32 v34, v34, v15
    v_mul_f32 v34, 0x3fb8aa3b, v34
    v_exp_f32 v34, v34
    v_add_f32 v13, v32, v33
    v_sub_f32 v35, v35, v15
    v_mul_f32 v35, 0x3fb8aa3b, v35
    v_exp_f32 v35, v35
    v_add_f32 v13, v13, v34
    v_sub_f32 v36, v36, v15
    v_mul_f32 v36, 0x3fb8aa3b, v36
    v_exp_f32 v36, v36
    v_add_f32 v13, v13, v35
    v_sub_f32 v37, v37, v15
    v_mul_f32 v37, 0x3fb8aa3b, v37
    v_exp_f32 v37, v37
    v_add_f32 v13, v13, v36
    v_sub_f32 v38, v38, v15
    v_mul_f32 v38, 0x3fb8aa3b, v38
    v_exp_f32 v38, v38
    v_add_f32 v13, v13, v37
    v_sub_f32 v39, v39, v15
    v_mul_f32 v39, 0x3fb8aa3b, v39
    v_exp_f32 v39, v39
    v_add_f32 v13, v13, v38
    v_sub_f32 v40, v40, v15
    v_mul_f32 v40, 0x3fb8aa3b, v40
    v_exp_f32 v40, v40
    v_add_f32 v13, v13, v39
    v_sub_f32 v41, v41, v15
    v_mul_f32 v41, 0x3fb8aa3b, v41
    v_exp_f32 v41, v41
    v_add_f32 v13, v13, v40
    v_sub_f32 v42, v42, v15
    v_mul_f32 v42, 0x3fb8aa3b, v42
    v_exp_f32 v42, v42
    v_add_f32 v13, v13, v41
    v_sub_f32 v43, v43, v15
    v_mul_f32 v43, 0x3fb8aa3b, v43
    v_exp_f32 v43, v43
    v_add_f32 v13, v13, v42
    v_sub_f32 v44, v44, v15
    v_mul_f32 v44, 0x3fb8aa3b, v44
    v_exp_f32 v44, v44
    v_add_f32 v13, v13, v43
    v_sub_f32 v45, v45, v15
    v_mul_f32 v45, 0x3fb8aa3b, v45
    v_exp_f32 v45, v45
    v_add_f32 v13, v13, v44
    v_sub_f32 v46, v46, v15
    v_mul_f32 v46, 0x3fb8aa3b, v46
    v_exp_f32 v46, v46
    v_add_f32 v13, v13, v45
    v_sub_f32 v47, v47, v15
    v_mul_f32 v47, 0x3fb8aa3b, v47
    v_exp_f32 v47, v47
    v_add_f32 v13, v13, v46
    v_sub_f32 v48, v48, v15
    v_mul_f32 v48, 0x3fb8aa3b, v48
    v_exp_f32 v48, v48
    v_add_f32 v13, v13, v47
    v_sub_f32 v49, v49, v15
    v_mul_f32 v49, 0x3fb8aa3b, v49
    v_exp_f32 v49, v49
    v_add_f32 v13, v13, v48
    v_sub_f32 v50, v50, v15
    v_mul_f32 v50, 0x3fb8aa3b, v50
    v_exp_f32 v50, v50
    v_add_f32 v13, v13, v49
    v_sub_f32 v51, v51, v15
    v_mul_f32 v51, 0x3fb8aa3b, v51
    v_exp_f32 v51, v51
    v_add_f32 v13, v13, v50
    v_sub_f32 v52, v52, v15
    v_mul_f32 v52, 0x3fb8aa3b, v52
    v_exp_f32 v52, v52
    v_add_f32 v13, v13, v51
    v_sub_f32 v53, v53, v15
    v_mul_f32 v53, 0x3fb8aa3b, v53
    v_exp_f32 v53, v53
    v_add_f32 v13, v13, v52
    v_sub_f32 v54, v54, v15
    v_mul_f32 v54, 0x3fb8aa3b, v54
    v_exp_f32 v54, v54
    v_add_f32 v13, v13, v53
    v_sub_f32 v55, v55, v15
    v_mul_f32 v55, 0x3fb8aa3b, v55
    v_exp_f32 v55, v55
    v_add_f32 v13, v13, v54
    v_sub_f32 v56, v56, v15
    v_mul_f32 v56, 0x3fb8aa3b, v56
    v_exp_f32 v56, v56
    v_add_f32 v13, v13, v55
    v_sub_f32 v57, v57, v15
    v_mul_f32 v57, 0x3fb8aa3b, v57
    v_exp_f32 v57, v57
    v_add_f32 v13, v13, v56
    v_sub_f32 v58, v58, v15
    v_mul_f32 v58, 0x3fb8aa3b, v58
    v_exp_f32 v58, v58
    v_add_f32 v13, v13, v57
    v_sub_f32 v59, v59, v15
    v_mul_f32 v59, 0x3fb8aa3b, v59
    v_exp_f32 v59, v59
    v_add_f32 v13, v13, v58
    v_sub_f32 v60, v60, v15
    v_mul_f32 v60, 0x3fb8aa3b, v60
    v_exp_f32 v60, v60
    v_add_f32 v13, v13, v59
    v_sub_f32 v61, v61, v15
    v_mul_f32 v61, 0x3fb8aa3b, v61
    v_exp_f32 v61, v61
    v_add_f32 v13, v13, v60
    v_sub_f32 v62, v62, v15
    v_mul_f32 v62, 0x3fb8aa3b, v62
    v_exp_f32 v62, v62
    v_add_f32 v13, v13, v61
    v_sub_f32 v63, v63, v15
    v_mul_f32 v63, 0x3fb8aa3b, v63
    v_exp_f32 v63, v63
    v_add_f32 v13, v13, v62
    v_add_f32 v13, v13, v63
    s_nop 1
    v_add_f32_dpp v13, v13, v13 row_ror:8 row_mask:0xf bank_mask:0xf
    v_mov_b32 v15, v13
    s_nop 1
    v_permlane16_swap_b32 v13, v15
    v_add_f32 v13, v13, v15
    v_mov_b32 v15, v13
    s_nop 1
    v_permlane32_swap_b32 v13, v15
    v_add_f32 v13, v13, v15
    s_mov_b64 exec, 1
    ds_write_b32 v14, v13 offset:10768
    s_mov_b64 exec, -1
    s_addk_i32 s84, 3072
    s_cmp_eq_u32 s84, s34
    s_cselect_b32 s84, 0, s84
    s_sub_u32 s83, s83, 1
    s_cselect_b32 s83, 0, s83
    s_cselect_b32 s3, s31, s2
    s_bitcmp1_b32 s3, 1
    s_cselect_b64 vcc, -1, 0
    buffer_load_dwordx4 v[124:127], v12, s[36:39], s84 offen offset:0 nt
    buffer_load_dwordx4 v[128:131], v12, s[36:39], s84 offen offset:128 nt
    buffer_load_dwordx4 v[132:135], v12, s[36:39], s84 offen offset:256 nt
    s_waitcnt lgkmcnt(0)
    s_barrier
    v_mov_b32 v13, 0
    ds_read_b128 v[8:11], v13 offset:10768
    s_waitcnt lgkmcnt(0)
    v_add_f32 v8, v8, v9
    v_add_f32 v10, v10, v11
    v_add_f32 v13, v8, v10
    v_rcp_f32 v13, v13
    s_nop 0
    v_mul_f32 v32, v32, v13
    v_cvt_pk_bf16_f32 v32, v32, v32
    v_mul_f32 v33, v33, v13
    v_cvt_pk_bf16_f32 v33, v33, v33
    v_mul_f32 v34, v34, v13
    v_cvt_pk_bf16_f32 v34, v34, v34
    v_mul_f32 v35, v35, v13
    v_cvt_pk_bf16_f32 v35, v35, v35
    v_mul_f32 v36, v36, v13
    v_cvt_pk_bf16_f32 v36, v36, v36
    v_mul_f32 v37, v37, v13
    v_cvt_pk_bf16_f32 v37, v37, v37
    v_mul_f32 v38, v38, v13
    v_cvt_pk_bf16_f32 v38, v38, v38
    v_mul_f32 v39, v39, v13
    v_cvt_pk_bf16_f32 v39, v39, v39
    v_mul_f32 v40, v40, v13
    v_cvt_pk_bf16_f32 v40, v40, v40
    v_mul_f32 v41, v41, v13
    v_cvt_pk_bf16_f32 v41, v41, v41
    v_mul_f32 v42, v42, v13
    v_cvt_pk_bf16_f32 v42, v42, v42
    v_mul_f32 v43, v43, v13
    v_cvt_pk_bf16_f32 v43, v43, v43
    v_mul_f32 v44, v44, v13
    v_cvt_pk_bf16_f32 v44, v44, v44
    v_mul_f32 v45, v45, v13
    v_cvt_pk_bf16_f32 v45, v45, v45
    v_mul_f32 v46, v46, v13
    v_cvt_pk_bf16_f32 v46, v46, v46
    v_mul_f32 v47, v47, v13
    v_cvt_pk_bf16_f32 v47, v47, v47
    v_mul_f32 v48, v48, v13
    v_cvt_pk_bf16_f32 v48, v48, v48
    v_mul_f32 v49, v49, v13
    v_cvt_pk_bf16_f32 v49, v49, v49
    v_mul_f32 v50, v50, v13
    v_cvt_pk_bf16_f32 v50, v50, v50
    v_mul_f32 v51, v51, v13
    v_cvt_pk_bf16_f32 v51, v51, v51
    v_mul_f32 v52, v52, v13
    v_cvt_pk_bf16_f32 v52, v52, v52
    v_mul_f32 v53, v53, v13
    v_cvt_pk_bf16_f32 v53, v53, v53
    v_mul_f32 v54, v54, v13
    v_cvt_pk_bf16_f32 v54, v54, v54
    v_mul_f32 v55, v55, v13
    v_cvt_pk_bf16_f32 v55, v55, v55
    v_mul_f32 v56, v56, v13
    v_cvt_pk_bf16_f32 v56, v56, v56
    v_mul_f32 v57, v57, v13
    v_cvt_pk_bf16_f32 v57, v57, v57
    v_mul_f32 v58, v58, v13
    v_cvt_pk_bf16_f32 v58, v58, v58
    v_mul_f32 v59, v59, v13
    v_cvt_pk_bf16_f32 v59, v59, v59
    v_mul_f32 v60, v60, v13
    v_cvt_pk_bf16_f32 v60, v60, v60
    v_mul_f32 v61, v61, v13
    v_cvt_pk_bf16_f32 v61, v61, v61
    v_mul_f32 v62, v62, v13
    v_cvt_pk_bf16_f32 v62, v62, v62
    v_mul_f32 v63, v63, v13
    v_cvt_pk_bf16_f32 v63, v63, v63
    s_mul_i32 s60, s30, 3072
    v_add_u32 v15, s60, v3
    v_bfe_u32 v172, v0, 2, 1
    v_lshrrev_b32 v175, 3, v0
    v_lshl_add_u32 v172, v172, 4, v175
    v_and_b32 v173, 3, v0
    v_lshlrev_b32 v173, 2, v173
    v_lshl_add_u32 v172, v172, 4, v173
    s_lshl_b32 s66, s30, 10
    s_add_u32 s66, s66, 10848
    v_add_u32 v172, s66, v172
    v_add_u32 v173, 640, v172
    v_and_b32 v174, 3, v175
    v_lshlrev_b32 v174, 8, v174
    v_lshrrev_b32 v175, 5, v0
    v_lshl_add_u32 v174, v175, 7, v174
    v_and_b32 v175, 7, v0
    v_lshl_add_u32 v174, v175, 1, v174
    s_mul_i32 s69, s28, 3
    s_add_u32 s69, s69, s30
    s_lshl_b32 s69, s69, 10
    s_lshl4_add_u32 s69, s29, s69
    v_and_b32 v8, v32, v28
    v_and_b32 v9, v32, v29
    v_and_b32 v10, v32, v30
    v_and_b32 v11, v32, v31
    s_waitcnt vmcnt(15)
    s_nop 0
    v_mfma_f32_16x16x32_bf16 v[16:19], v[8:11], v[64:67], 0
    v_mfma_f32_16x16x32_bf16 v[20:23], v[8:11], v[68:71], 0
    v_mfma_f32_16x16x32_bf16 v[24:27], v[8:11], v[72:75], 0
    v_and_b32 v4, v33, v28
    v_and_b32 v5, v33, v29
    v_and_b32 v6, v33, v30
    v_and_b32 v7, v33, v31
    s_waitcnt vmcnt(12)
    s_nop 0
    v_mfma_f32_16x16x32_bf16 v[16:19], v[4:7], v[76:79], v[16:19]
    v_mfma_f32_16x16x32_bf16 v[20:23], v[4:7], v[80:83], v[20:23]
    v_mfma_f32_16x16x32_bf16 v[24:27], v[4:7], v[84:87], v[24:27]
    s_addk_i32 s84, 3072
    s_cmp_eq_u32 s84, s34
    s_cselect_b32 s84, 0, s84
    s_sub_u32 s83, s83, 1
    s_cselect_b32 s83, 0, s83
    s_cselect_b32 s3, s31, s2
    s_bitcmp1_b32 s3, 1
    s_cselect_b64 vcc, -1, 0
    s_bitcmp1_b32 s3, 0
    s_waitcnt vmcnt(6)
    s_cbranch_vccnz L_hi102
    s_waitcnt vmcnt(4)
    s_cbranch_scc1 L_go102
    s_waitcnt vmcnt(3)
L_hi102:
    s_cbranch_scc1 L_go102
    s_waitcnt vmcnt(5)
L_go102:
    buffer_load_dwordx4 v[64:67], v12, s[36:39], s84 offen offset:0 nt
    s_bitcmp1_b32 s3, 0
    s_waitcnt vmcnt(6)
    s_cbranch_vccnz L_hi103
    s_waitcnt vmcnt(4)
    s_cbranch_scc1 L_go103
    s_waitcnt vmcnt(3)
L_hi103:
    s_cbranch_scc1 L_go103
    s_waitcnt vmcnt(5)
L_go103:
    buffer_load_dwordx4 v[68:71], v12, s[36:39], s84 offen offset:128 nt
    s_bitcmp1_b32 s3, 0
    s_waitcnt vmcnt(6)
    s_cbranch_vccnz L_hi104
    s_waitcnt vmcnt(4)
    s_cbranch_scc1 L_go104
    s_waitcnt vmcnt(3)
L_hi104:
    s_cbranch_scc1 L_go104
    s_waitcnt vmcnt(5)
L_go104:
    buffer_load_dwordx4 v[72:75], v12, s[36:39], s84 offen offset:256 nt
    v_mov_b32 v13, 0
    ds_read_b32 v13, v13 offset:10820
    s_waitcnt lgkmcnt(0)
    v_readfirstlane_b32 s63, v13
    s_cmp_eq_u32 s63, 0
    s_cselect_b32 s63, 16, s63
    s_cmp_eq_u32 s26, 0
    s_cselect_b32 s64, 4, 0
    s_sub_i32 s63, s63, s64
    s_sub_i32 s64, 16, s63
    s_max_i32 s64, s64, 0
    s_sub_i32 s65, s63, 20
    s_max_i32 s65, s65, 0
    s_cmp_lg_u32 s65, 0
    s_cselect_b32 s66, 1, -1
    s_add_i32 s2, s31, s66
    s_min_u32 s2, s2, 3
    s_add_u32 s64, s64, s65
    s_mul_i32 s83, s64, 2
    s_lshr_b32 s83, s83, 2
    v_and_b32 v8, v34, v28
    v_and_b32 v9, v34, v29
    v_and_b32 v10, v34, v30
    v_and_b32 v11, v34, v31
    s_nop 1
    v_mfma_f32_16x16x32_bf16 v[16:19], v[8:11], v[88:91], v[16:19]
    v_mfma_f32_16x16x32_bf16 v[20:23], v[8:11], v[92:95], v[20:23]
    v_mfma_f32_16x16x32_bf16 v[24:27], v[8:11], v[96:99], v[24:27]
    v_and_b32 v4, v35, v28
    v_and_b32 v5, v35, v29
    v_and_b32 v6, v35, v30
    v_and_b32 v7, v35, v31
    s_nop 1
    v_mfma_f32_16x16x32_bf16 v[16:19], v[4:7], v[100:103], v[16:19]
    v_mfma_f32_16x16x32_bf16 v[20:23], v[4:7], v[104:107], v[20:23]
    v_mfma_f32_16x16x32_bf16 v[24:27], v[4:7], v[108:111], v[24:27]
    s_addk_i32 s84, 3072
    s_cmp_eq_u32 s84, s34
    s_cselect_b32 s84, 0, s84
    s_sub_u32 s83, s83, 1
    s_cselect_b32 s83, 0, s83
    s_cselect_b32 s3, s31, s2
    s_bitcmp1_b32 s3, 1
    s_cselect_b64 vcc, -1, 0
    s_bitcmp1_b32 s3, 0
    s_waitcnt vmcnt(6)
    s_cbranch_vccnz L_hi105
    s_waitcnt vmcnt(4)
    s_cbranch_scc1 L_go105
    s_waitcnt vmcnt(3)
L_hi105:
    s_cbranch_scc1 L_go105
    s_waitcnt vmcnt(5)
L_go105:
    buffer_load_dwordx4 v[76:79], v12, s[36:39], s84 offen offset:0 nt
    s_bitcmp1_b32 s3, 0
    s_waitcnt vmcnt(6)
    s_cbranch_vccnz L_hi106
    s_waitcnt vmcnt(4)
    s_cbranch_scc1 L_go106
    s_waitcnt vmcnt(3)
L_hi106:
    s_cbranch_scc1 L_go106
    s_waitcnt vmcnt(5)
L_go106:
    buffer_load_dwordx4 v[80:83], v12, s[36:39], s84 offen offset:128 nt
    s_bitcmp1_b32 s3, 0
    s_waitcnt vmcnt(6)
    s_cbranch_vccnz L_hi107
    s_waitcnt vmcnt(4)
    s_cbranch_scc1 L_go107
    s_waitcnt vmcnt(3)
L_hi107:
    s_cbranch_scc1 L_go107
    s_waitcnt vmcnt(5)
L_go107:
    buffer_load_dwordx4 v[84:87], v12, s[36:39], s84 offen offset:256 nt
    v_and_b32 v8, v36, v28
    v_and_b32 v9, v36, v29
    v_and_b32 v10, v36, v30
    v_and_b32 v11, v36, v31
    s_nop 1
    v_mfma_f32_16x16x32_bf16 v[16:19], v[8:11], v[112:115], v[16:19]
    v_mfma_f32_16x16x32_bf16 v[20:23], v[8:11], v[116:119], v[20:23]
    v_mfma_f32_16x16x32_bf16 v[24:27], v[8:11], v[120:123], v[24:27]
    s_addk_i32 s84, 3072
    s_cmp_eq_u32 s84, s34
    s_cselect_b32 s84, 0, s84
    s_sub_u32 s83, s83, 1
    s_cselect_b32 s83, 0, s83
    s_cselect_b32 s3, s31, s2
    s_bitcmp1_b32 s3, 1
    s_cselect_b64 vcc, -1, 0
    s_bitcmp1_b32 s3, 0
    s_waitcnt vmcnt(6)
    s_cbranch_vccnz L_hi108
    s_waitcnt vmcnt(4)
    s_cbranch_scc1 L_go108
    s_waitcnt vmcnt(3)
L_hi108:
    s_cbranch_scc1 L_go108
    s_waitcnt vmcnt(5)
L_go108:
    buffer_load_dwordx4 v[88:91], v12, s[36:39], s84 offen offset:0 nt
    s_bitcmp1_b32 s3, 0
    s_waitcnt vmcnt(6)
    s_cbranch_vccnz L_hi109
    s_waitcnt vmcnt(4)
    s_cbranch_scc1 L_go109
    s_waitcnt vmcnt(3)
L_hi109:
    s_cbranch_scc1 L_go109
    s_waitcnt vmcnt(5)
L_go109:
    buffer_load_dwordx4 v[92:95], v12, s[36:39], s84 offen offset:128 nt
    s_bitcmp1_b32 s3, 0
    s_waitcnt vmcnt(6)
    s_cbranch_vccnz L_hi110
    s_waitcnt vmcnt(4)
    s_cbranch_scc1 L_go110
    s_waitcnt vmcnt(3)
L_hi110:
    s_cbranch_scc1 L_go110
    s_waitcnt vmcnt(5)
L_go110:
    buffer_load_dwordx4 v[96:99], v12, s[36:39], s84 offen offset:256 nt
    v_and_b32 v4, v37, v28
    v_and_b32 v5, v37, v29
    v_and_b32 v6, v37, v30
    v_and_b32 v7, v37, v31
    s_nop 1
    v_mfma_f32_16x16x32_bf16 v[16:19], v[4:7], v[124:127], v[16:19]
    v_mfma_f32_16x16x32_bf16 v[20:23], v[4:7], v[128:131], v[20:23]
    v_mfma_f32_16x16x32_bf16 v[24:27], v[4:7], v[132:135], v[24:27]
    s_addk_i32 s84, 3072
    s_cmp_eq_u32 s84, s34
    s_cselect_b32 s84, 0, s84
    s_sub_u32 s83, s83, 1
    s_cselect_b32 s83, 0, s83
    s_cselect_b32 s3, s31, s2
    s_bitcmp1_b32 s3, 1
    s_cselect_b64 vcc, -1, 0
    s_bitcmp1_b32 s3, 0
    s_waitcnt vmcnt(6)
    s_cbranch_vccnz L_hi111
    s_waitcnt vmcnt(4)
    s_cbranch_scc1 L_go111
    s_waitcnt vmcnt(3)
L_hi111:
    s_cbranch_scc1 L_go111
    s_waitcnt vmcnt(5)
L_go111:
    buffer_load_dwordx4 v[100:103], v12, s[36:39], s84 offen offset:0 nt
    s_bitcmp1_b32 s3, 0
    s_waitcnt vmcnt(6)
    s_cbranch_vccnz L_hi112
    s_waitcnt vmcnt(4)
    s_cbranch_scc1 L_go112
    s_waitcnt vmcnt(3)
L_hi112:
    s_cbranch_scc1 L_go112
    s_waitcnt vmcnt(5)
L_go112:
    buffer_load_dwordx4 v[104:107], v12, s[36:39], s84 offen offset:128 nt
    s_bitcmp1_b32 s3, 0
    s_waitcnt vmcnt(6)
    s_cbranch_vccnz L_hi113
    s_waitcnt vmcnt(4)
    s_cbranch_scc1 L_go113
    s_waitcnt vmcnt(3)
L_hi113:
    s_cbranch_scc1 L_go113
    s_waitcnt vmcnt(5)
L_go113:
    buffer_load_dwordx4 v[108:111], v12, s[36:39], s84 offen offset:256 nt
    v_and_b32 v8, v38, v28
    v_and_b32 v9, v38, v29
    v_and_b32 v10, v38, v30
    v_and_b32 v11, v38, v31
    s_nop 1
    v_mfma_f32_16x16x32_bf16 v[16:19], v[8:11], v[64:67], v[16:19]
    v_mfma_f32_16x16x32_bf16 v[20:23], v[8:11], v[68:71], v[20:23]
    v_mfma_f32_16x16x32_bf16 v[24:27], v[8:11], v[72:75], v[24:27]
    s_addk_i32 s84, 3072
    s_cmp_eq_u32 s84, s34
    s_cselect_b32 s84, 0, s84
    s_sub_u32 s83, s83, 1
    s_cselect_b32 s83, 0, s83
    s_cselect_b32 s3, s31, s2
    s_bitcmp1_b32 s3, 1
    s_cselect_b64 vcc, -1, 0
    s_bitcmp1_b32 s3, 0
    s_waitcnt vmcnt(6)
    s_cbranch_vccnz L_hi114
    s_waitcnt vmcnt(4)
    s_cbranch_scc1 L_go114
    s_waitcnt vmcnt(3)
L_hi114:
    s_cbranch_scc1 L_go114
    s_waitcnt vmcnt(5)
L_go114:
    buffer_load_dwordx4 v[64:67], v12, s[36:39], s84 offen offset:0 nt
    s_bitcmp1_b32 s3, 0
    s_waitcnt vmcnt(6)
    s_cbranch_vccnz L_hi115
    s_waitcnt vmcnt(4)
    s_cbranch_scc1 L_go115
    s_waitcnt vmcnt(3)
L_hi115:
    s_cbranch_scc1 L_go115
    s_waitcnt vmcnt(5)
L_go115:
    buffer_load_dwordx4 v[68:71], v12, s[36:39], s84 offen offset:128 nt
    s_bitcmp1_b32 s3, 0
    s_waitcnt vmcnt(6)
    s_cbranch_vccnz L_hi116
    s_waitcnt vmcnt(4)
    s_cbranch_scc1 L_go116
    s_waitcnt vmcnt(3)
L_hi116:
    s_cbranch_scc1 L_go116
    s_waitcnt vmcnt(5)
L_go116:
    buffer_load_dwordx4 v[72:75], v12, s[36:39], s84 offen offset:256 nt
    v_mov_b32 v13, 0
    v_mov_b32 v14, 2
    ds_max_u32 v13, v14 offset:10796
    v_and_b32 v4, v39, v28
    v_and_b32 v5, v39, v29
    v_and_b32 v6, v39, v30
    v_and_b32 v7, v39, v31
    s_nop 1
    v_mfma_f32_16x16x32_bf16 v[16:19], v[4:7], v[76:79], v[16:19]
    v_mfma_f32_16x16x32_bf16 v[20:23], v[4:7], v[80:83], v[20:23]
    v_mfma_f32_16x16x32_bf16 v[24:27], v[4:7], v[84:87], v[24:27]
    s_addk_i32 s84, 3072
    s_cmp_eq_u32 s84, s34
    s_cselect_b32 s84, 0, s84
    s_sub_u32 s83, s83, 1
    s_cselect_b32 s83, 0, s83
    s_cselect_b32 s3, s31, s2
    s_bitcmp1_b32 s3, 1
    s_cselect_b64 vcc, -1, 0
    s_bitcmp1_b32 s3, 0
    s_waitcnt vmcnt(6)
    s_cbranch_vccnz L_hi117
    s_waitcnt vmcnt(4)
    s_cbranch_scc1 L_go117
    s_waitcnt vmcnt(3)
L_hi117:
    s_cbranch_scc1 L_go117
    s_waitcnt vmcnt(5)
L_go117:
    buffer_load_dwordx4 v[76:79], v12, s[36:39], s84 offen offset:0 nt
    s_bitcmp1_b32 s3, 0
    s_waitcnt vmcnt(6)
    s_cbranch_vccnz L_hi118
    s_waitcnt vmcnt(4)
    s_cbranch_scc1 L_go118
    s_waitcnt vmcnt(3)
L_hi118:
    s_cbranch_scc1 L_go118
    s_waitcnt vmcnt(5)
L_go118:
    buffer_load_dwordx4 v[80:83], v12, s[36:39], s84 offen offset:128 nt
    s_bitcmp1_b32 s3, 0
    s_waitcnt vmcnt(6)
    s_cbranch_vccnz L_hi119
    s_waitcnt vmcnt(4)
    s_cbranch_scc1 L_go119
    s_waitcnt vmcnt(3)
L_hi119:
    s_cbranch_scc1 L_go119
    s_waitcnt vmcnt(5)
L_go119:
    buffer_load_dwordx4 v[84:87], v12, s[36:39], s84 offen offset:256 nt
    v_and_b32 v8, v40, v28
    v_and_b32 v9, v40, v29
    v_and_b32 v10, v40, v30
    v_and_b32 v11, v40, v31
    s_nop 1
    v_mfma_f32_16x16x32_bf16 v[16:19], v[8:11], v[88:91], v[16:19]
    v_mfma_f32_16x16x32_bf16 v[20:23], v[8:11], v[92:95], v[20:23]
    v_mfma_f32_16x16x32_bf16 v[24:27], v[8:11], v[96:99], v[24:27]
    s_addk_i32 s84, 3072
    s_cmp_eq_u32 s84, s34
    s_cselect_b32 s84, 0, s84
    s_sub_u32 s83, s83, 1
    s_cselect_b32 s83, 0, s83
    s_cselect_b32 s3, s31, s2
    s_bitcmp1_b32 s3, 1
    s_cselect_b64 vcc, -1, 0
    s_bitcmp1_b32 s3, 0
    s_waitcnt vmcnt(6)
    s_cbranch_vccnz L_hi120
    s_waitcnt vmcnt(4)
    s_cbranch_scc1 L_go120
    s_waitcnt vmcnt(3)
L_hi120:
    s_cbranch_scc1 L_go120
    s_waitcnt vmcnt(5)
L_go120:
    buffer_load_dwordx4 v[88:91], v12, s[36:39], s84 offen offset:0 nt
    s_bitcmp1_b32 s3, 0
    s_waitcnt vmcnt(6)
    s_cbranch_vccnz L_hi121
    s_waitcnt vmcnt(4)
    s_cbranch_scc1 L_go121
    s_waitcnt vmcnt(3)
L_hi121:
    s_cbranch_scc1 L_go121
    s_waitcnt vmcnt(5)
L_go121:
    buffer_load_dwordx4 v[92:95], v12, s[36:39], s84 offen offset:128 nt
    s_bitcmp1_b32 s3, 0
    s_waitcnt vmcnt(6)
    s_cbranch_vccnz L_hi122
    s_waitcnt vmcnt(4)
    s_cbranch_scc1 L_go122
    s_waitcnt vmcnt(3)
L_hi122:
    s_cbranch_scc1 L_go122
    s_waitcnt vmcnt(5)
L_go122:
    buffer_load_dwordx4 v[96:99], v12, s[36:39], s84 offen offset:256 nt
    v_and_b32 v4, v41, v28
    v_and_b32 v5, v41, v29
    v_and_b32 v6, v41, v30
    v_and_b32 v7, v41, v31
    s_nop 1
    v_mfma_f32_16x16x32_bf16 v[16:19], v[4:7], v[100:103], v[16:19]
    v_mfma_f32_16x16x32_bf16 v[20:23], v[4:7], v[104:107], v[20:23]
    v_mfma_f32_16x16x32_bf16 v[24:27], v[4:7], v[108:111], v[24:27]
    s_addk_i32 s84, 3072
    s_cmp_eq_u32 s84, s34
    s_cselect_b32 s84, 0, s84
    s_sub_u32 s83, s83, 1
    s_cselect_b32 s83, 0, s83
    s_cselect_b32 s3, s31, s2
    s_bitcmp1_b32 s3, 1
    s_cselect_b64 vcc, -1, 0
    s_bitcmp1_b32 s3, 0
    s_waitcnt vmcnt(6)
    s_cbranch_vccnz L_hi123
    s_waitcnt vmcnt(4)
    s_cbranch_scc1 L_go123
    s_waitcnt vmcnt(3)
L_hi123:
    s_cbranch_scc1 L_go123
    s_waitcnt vmcnt(5)
L_go123:
    buffer_load_dwordx4 v[100:103], v12, s[36:39], s84 offen offset:0 nt
    s_bitcmp1_b32 s3, 0
    s_waitcnt vmcnt(6)
    s_cbranch_vccnz L_hi124
    s_waitcnt vmcnt(4)
    s_cbranch_scc1 L_go124
    s_waitcnt vmcnt(3)
L_hi124:
    s_cbranch_scc1 L_go124
    s_waitcnt vmcnt(5)
L_go124:
    buffer_load_dwordx4 v[104:107], v12, s[36:39], s84 offen offset:128 nt
    s_bitcmp1_b32 s3, 0
    s_waitcnt vmcnt(6)
    s_cbranch_vccnz L_hi125
    s_waitcnt vmcnt(4)
    s_cbranch_scc1 L_go125
    s_waitcnt vmcnt(3)
L_hi125:
    s_cbranch_scc1 L_go125
    s_waitcnt vmcnt(5)
L_go125:
    buffer_load_dwordx4 v[108:111], v12, s[36:39], s84 offen offset:256 nt
    v_mov_b32 v13, 0
    ds_read_b32 v13, v13 offset:10828
    s_waitcnt lgkmcnt(0)
    v_readfirstlane_b32 s63, v13
    s_cmp_eq_u32 s63, 0
    s_cselect_b32 s63, 16, s63
    s_cmp_eq_u32 s26, 0
    s_cselect_b32 s64, 4, 0
    s_sub_i32 s63, s63, s64
    s_sub_i32 s64, 16, s63
    s_max_i32 s64, s64, 0
    s_sub_i32 s65, s63, 20
    s_max_i32 s65, s65, 0
    s_cmp_lg_u32 s65, 0
    s_cselect_b32 s66, 1, -1
    s_add_i32 s2, s31, s66
    s_min_u32 s2, s2, 3
    s_add_u32 s64, s64, s65
    s_mul_i32 s83, s64, 2
    s_lshr_b32 s83, s83, 2
    v_and_b32 v8, v42, v28
    v_and_b32 v9, v42, v29
    v_and_b32 v10, v42, v30
    v_and_b32 v11, v42, v31
    s_nop 1
    v_mfma_f32_16x16x32_bf16 v[16:19], v[8:11], v[64:67], v[16:19]
    v_mfma_f32_16x16x32_bf16 v[20:23], v[8:11], v[68:71], v[20:23]
    v_mfma_f32_16x16x32_bf16 v[24:27], v[8:11], v[72:75], v[24:27]
    s_addk_i32 s84, 3072
    s_cmp_eq_u32 s84, s34
    s_cselect_b32 s84, 0, s84
    s_sub_u32 s83, s83, 1
    s_cselect_b32 s83, 0, s83
    s_cselect_b32 s3, s31, s2
    s_bitcmp1_b32 s3, 1
    s_cselect_b64 vcc, -1, 0
    s_bitcmp1_b32 s3, 0
    s_waitcnt vmcnt(6)
    s_cbranch_vccnz L_hi126
    s_waitcnt vmcnt(4)
    s_cbranch_scc1 L_go126
    s_waitcnt vmcnt(3)
L_hi126:
    s_cbranch_scc1 L_go126
    s_waitcnt vmcnt(5)
L_go126:
    buffer_load_dwordx4 v[64:67], v12, s[36:39], s84 offen offset:0 nt
    s_bitcmp1_b32 s3, 0
    s_waitcnt vmcnt(6)
    s_cbranch_vccnz L_hi127
    s_waitcnt vmcnt(4)
    s_cbranch_scc1 L_go127
    s_waitcnt vmcnt(3)
L_hi127:
    s_cbranch_scc1 L_go127
    s_waitcnt vmcnt(5)
L_go127:
    buffer_load_dwordx4 v[68:71], v12, s[36:39], s84 offen offset:128 nt
    s_bitcmp1_b32 s3, 0
    s_waitcnt vmcnt(6)
    s_cbranch_vccnz L_hi128
    s_waitcnt vmcnt(4)
    s_cbranch_scc1 L_go128
    s_waitcnt vmcnt(3)
L_hi128:
    s_cbranch_scc1 L_go128
    s_waitcnt vmcnt(5)
L_go128:
    buffer_load_dwordx4 v[72:75], v12, s[36:39], s84 offen offset:256 nt
    v_and_b32 v4, v43, v28
    v_and_b32 v5, v43, v29
    v_and_b32 v6, v43, v30
    v_and_b32 v7, v43, v31
    s_nop 1
    v_mfma_f32_16x16x32_bf16 v[16:19], v[4:7], v[76:79], v[16:19]
    v_mfma_f32_16x16x32_bf16 v[20:23], v[4:7], v[80:83], v[20:23]
    v_mfma_f32_16x16x32_bf16 v[24:27], v[4:7], v[84:87], v[24:27]
    s_addk_i32 s84, 3072
    s_cmp_eq_u32 s84, s34
    s_cselect_b32 s84, 0, s84
    s_sub_u32 s83, s83, 1
    s_cselect_b32 s83, 0, s83
    s_cselect_b32 s3, s31, s2
    s_bitcmp1_b32 s3, 1
    s_cselect_b64 vcc, -1, 0
    s_bitcmp1_b32 s3, 0
    s_waitcnt vmcnt(6)
    s_cbranch_vccnz L_hi129
    s_waitcnt vmcnt(4)
    s_cbranch_scc1 L_go129
    s_waitcnt vmcnt(3)
L_hi129:
    s_cbranch_scc1 L_go129
    s_waitcnt vmcnt(5)
L_go129:
    buffer_load_dwordx4 v[76:79], v12, s[36:39], s84 offen offset:0 nt
    s_bitcmp1_b32 s3, 0
    s_waitcnt vmcnt(6)
    s_cbranch_vccnz L_hi130
    s_waitcnt vmcnt(4)
    s_cbranch_scc1 L_go130
    s_waitcnt vmcnt(3)
L_hi130:
    s_cbranch_scc1 L_go130
    s_waitcnt vmcnt(5)
L_go130:
    buffer_load_dwordx4 v[80:83], v12, s[36:39], s84 offen offset:128 nt
    s_bitcmp1_b32 s3, 0
    s_waitcnt vmcnt(6)
    s_cbranch_vccnz L_hi131
    s_waitcnt vmcnt(4)
    s_cbranch_scc1 L_go131
    s_waitcnt vmcnt(3)
L_hi131:
    s_cbranch_scc1 L_go131
    s_waitcnt vmcnt(5)
L_go131:
    buffer_load_dwordx4 v[84:87], v12, s[36:39], s84 offen offset:256 nt
    v_mov_b32 v13, 0
    v_mov_b32 v14, 3
    ds_max_u32 v13, v14 offset:10796
    v_and_b32 v8, v44, v28
    v_and_b32 v9, v44, v29
    v_and_b32 v10, v44, v30
    v_and_b32 v11, v44, v31
    s_nop 1
    v_mfma_f32_16x16x32_bf16 v[16:19], v[8:11], v[88:91], v[16:19]
    v_mfma_f32_16x16x32_bf16 v[20:23], v[8:11], v[92:95], v[20:23]
    v_mfma_f32_16x16x32_bf16 v[24:27], v[8:11], v[96:99], v[24:27]
    s_addk_i32 s84, 3072
    s_cmp_eq_u32 s84, s34
    s_cselect_b32 s84, 0, s84
    s_sub_u32 s83, s83, 1
    s_cselect_b32 s83, 0, s83
    s_cselect_b32 s3, s31, s2
    s_bitcmp1_b32 s3, 1
    s_cselect_b64 vcc, -1, 0
    s_bitcmp1_b32 s3, 0
    s_waitcnt vmcnt(6)
    s_cbranch_vccnz L_hi132
    s_waitcnt vmcnt(4)
    s_cbranch_scc1 L_go132
    s_waitcnt vmcnt(3)
L_hi132:
    s_cbranch_scc1 L_go132
    s_waitcnt vmcnt(5)
L_go132:
    buffer_load_dwordx4 v[88:91], v12, s[36:39], s84 offen offset:0 nt
    s_bitcmp1_b32 s3, 0
    s_waitcnt vmcnt(6)
    s_cbranch_vccnz L_hi133
    s_waitcnt vmcnt(4)
    s_cbranch_scc1 L_go133
    s_waitcnt vmcnt(3)
L_hi133:
    s_cbranch_scc1 L_go133
    s_waitcnt vmcnt(5)
L_go133:
    buffer_load_dwordx4 v[92:95], v12, s[36:39], s84 offen offset:128 nt
    s_bitcmp1_b32 s3, 0
    s_waitcnt vmcnt(6)
    s_cbranch_vccnz L_hi134
    s_waitcnt vmcnt(4)
    s_cbranch_scc1 L_go134
    s_waitcnt vmcnt(3)
L_hi134:
    s_cbranch_scc1 L_go134
    s_waitcnt vmcnt(5)
L_go134:
    buffer_load_dwordx4 v[96:99], v12, s[36:39], s84 offen offset:256 nt
    v_and_b32 v4, v45, v28
    v_and_b32 v5, v45, v29
    v_and_b32 v6, v45, v30
    v_and_b32 v7, v45, v31
    s_nop 1
    v_mfma_f32_16x16x32_bf16 v[16:19], v[4:7], v[100:103], v[16:19]
    v_mfma_f32_16x16x32_bf16 v[20:23], v[4:7], v[104:107], v[20:23]
    v_mfma_f32_16x16x32_bf16 v[24:27], v[4:7], v[108:111], v[24:27]
    s_addk_i32 s84, 3072
    s_cmp_eq_u32 s84, s34
    s_cselect_b32 s84, 0, s84
    s_sub_u32 s83, s83, 1
    s_cselect_b32 s83, 0, s83
    s_cselect_b32 s3, s31, s2
    s_bitcmp1_b32 s3, 1
    s_cselect_b64 vcc, -1, 0
    s_bitcmp1_b32 s3, 0
    s_waitcnt vmcnt(6)
    s_cbranch_vccnz L_hi135
    s_waitcnt vmcnt(4)
    s_cbranch_scc1 L_go135
    s_waitcnt vmcnt(3)
L_hi135:
    s_cbranch_scc1 L_go135
    s_waitcnt vmcnt(5)
L_go135:
    buffer_load_dwordx4 v[100:103], v12, s[36:39], s84 offen offset:0 nt
    s_bitcmp1_b32 s3, 0
    s_waitcnt vmcnt(6)
    s_cbranch_vccnz L_hi136
    s_waitcnt vmcnt(4)
    s_cbranch_scc1 L_go136
    s_waitcnt vmcnt(3)
L_hi136:
    s_cbranch_scc1 L_go136
    s_waitcnt vmcnt(5)
L_go136:
    buffer_load_dwordx4 v[104:107], v12, s[36:39], s84 offen offset:128 nt
    s_bitcmp1_b32 s3, 0
    s_waitcnt vmcnt(6)
    s_cbranch_vccnz L_hi137
    s_waitcnt vmcnt(4)
    s_cbranch_scc1 L_go137
    s_waitcnt vmcnt(3)
L_hi137:
    s_cbranch_scc1 L_go137
    s_waitcnt vmcnt(5)
L_go137:
    buffer_load_dwordx4 v[108:111], v12, s[36:39], s84 offen offset:256 nt
    v_and_b32 v8, v46, v28
    v_and_b32 v9, v46, v29
    v_and_b32 v10, v46, v30
    v_and_b32 v11, v46, v31
    s_nop 1
    v_mfma_f32_16x16x32_bf16 v[16:19], v[8:11], v[64:67], v[16:19]
    v_mfma_f32_16x16x32_bf16 v[20:23], v[8:11], v[68:71], v[20:23]
    v_mfma_f32_16x16x32_bf16 v[24:27], v[8:11], v[72:75], v[24:27]
    s_addk_i32 s84, 3072
    s_cmp_eq_u32 s84, s34
    s_cselect_b32 s84, 0, s84
    s_sub_u32 s83, s83, 1
    s_cselect_b32 s83, 0, s83
    s_cselect_b32 s3, s31, s2
    s_bitcmp1_b32 s3, 1
    s_cselect_b64 vcc, -1, 0
    s_bitcmp1_b32 s3, 0
    s_waitcnt vmcnt(6)
    s_cbranch_vccnz L_hi138
    s_waitcnt vmcnt(4)
    s_cbranch_scc1 L_go138
    s_waitcnt vmcnt(3)
L_hi138:
    s_cbranch_scc1 L_go138
    s_waitcnt vmcnt(5)
L_go138:
    buffer_load_dwordx4 v[64:67], v12, s[36:39], s84 offen offset:0 nt
    s_bitcmp1_b32 s3, 0
    s_waitcnt vmcnt(6)
    s_cbranch_vccnz L_hi139
    s_waitcnt vmcnt(4)
    s_cbranch_scc1 L_go139
    s_waitcnt vmcnt(3)
L_hi139:
    s_cbranch_scc1 L_go139
    s_waitcnt vmcnt(5)
L_go139:
    buffer_load_dwordx4 v[68:71], v12, s[36:39], s84 offen offset:128 nt
    s_bitcmp1_b32 s3, 0
    s_waitcnt vmcnt(6)
    s_cbranch_vccnz L_hi140
    s_waitcnt vmcnt(4)
    s_cbranch_scc1 L_go140
    s_waitcnt vmcnt(3)
L_hi140:
    s_cbranch_scc1 L_go140
    s_waitcnt vmcnt(5)
L_go140:
    buffer_load_dwordx4 v[72:75], v12, s[36:39], s84 offen offset:256 nt
    v_mov_b32 v13, 0
    ds_read_b32 v13, v13 offset:10832
    s_waitcnt lgkmcnt(0)
    v_readfirstlane_b32 s63, v13
    s_cmp_eq_u32 s63, 0
    s_cselect_b32 s63, 16, s63
    s_cmp_eq_u32 s26, 0
    s_cselect_b32 s64, 4, 0
    s_sub_i32 s63, s63, s64
    s_sub_i32 s64, 16, s63
    s_max_i32 s64, s64, 0
    s_sub_i32 s65, s63, 20
    s_max_i32 s65, s65, 0
    s_cmp_lg_u32 s65, 0
    s_cselect_b32 s66, 1, -1
    s_add_i32 s2, s31, s66
    s_min_u32 s2, s2, 3
    s_add_u32 s64, s64, s65
    s_mul_i32 s83, s64, 2
    s_lshr_b32 s83, s83, 2
    v_and_b32 v4, v47, v28
    v_and_b32 v5, v47, v29
    v_and_b32 v6, v47, v30
    v_and_b32 v7, v47, v31
    s_nop 1
    v_mfma_f32_16x16x32_bf16 v[16:19], v[4:7], v[76:79], v[16:19]
    v_mfma_f32_16x16x32_bf16 v[20:23], v[4:7], v[80:83], v[20:23]
    v_mfma_f32_16x16x32_bf16 v[24:27], v[4:7], v[84:87], v[24:27]
    s_addk_i32 s84, 3072
    s_cmp_eq_u32 s84, s34
    s_cselect_b32 s84, 0, s84
    s_sub_u32 s83, s83, 1
    s_cselect_b32 s83, 0, s83
    s_cselect_b32 s3, s31, s2
    s_bitcmp1_b32 s3, 1
    s_cselect_b64 vcc, -1, 0
    s_bitcmp1_b32 s3, 0
    s_waitcnt vmcnt(6)
    s_cbranch_vccnz L_hi141
    s_waitcnt vmcnt(4)
    s_cbranch_scc1 L_go141
    s_waitcnt vmcnt(3)
L_hi141:
    s_cbranch_scc1 L_go141
    s_waitcnt vmcnt(5)
L_go141:
    buffer_load_dwordx4 v[76:79], v12, s[36:39], s84 offen offset:0 nt
    s_bitcmp1_b32 s3, 0
    s_waitcnt vmcnt(6)
    s_cbranch_vccnz L_hi142
    s_waitcnt vmcnt(4)
    s_cbranch_scc1 L_go142
    s_waitcnt vmcnt(3)
L_hi142:
    s_cbranch_scc1 L_go142
    s_waitcnt vmcnt(5)
L_go142:
    buffer_load_dwordx4 v[80:83], v12, s[36:39], s84 offen offset:128 nt
    s_bitcmp1_b32 s3, 0
    s_waitcnt vmcnt(6)
    s_cbranch_vccnz L_hi143
    s_waitcnt vmcnt(4)
    s_cbranch_scc1 L_go143
    s_waitcnt vmcnt(3)
L_hi143:
    s_cbranch_scc1 L_go143
    s_waitcnt vmcnt(5)
L_go143:
    buffer_load_dwordx4 v[84:87], v12, s[36:39], s84 offen offset:256 nt
    v_and_b32 v8, v48, v28
    v_and_b32 v9, v48, v29
    v_and_b32 v10, v48, v30
    v_and_b32 v11, v48, v31
    s_nop 1
    v_mfma_f32_16x16x32_bf16 v[16:19], v[8:11], v[88:91], v[16:19]
    v_mfma_f32_16x16x32_bf16 v[20:23], v[8:11], v[92:95], v[20:23]
    v_mfma_f32_16x16x32_bf16 v[24:27], v[8:11], v[96:99], v[24:27]
    s_addk_i32 s84, 3072
    s_cmp_eq_u32 s84, s34
    s_cselect_b32 s84, 0, s84
    s_sub_u32 s83, s83, 1
    s_cselect_b32 s83, 0, s83
    s_cselect_b32 s3, s31, s2
    s_bitcmp1_b32 s3, 1
    s_cselect_b64 vcc, -1, 0
    s_bitcmp1_b32 s3, 0
    s_waitcnt vmcnt(6)
    s_cbranch_vccnz L_hi144
    s_waitcnt vmcnt(4)
    s_cbranch_scc1 L_go144
    s_waitcnt vmcnt(3)
L_hi144:
    s_cbranch_scc1 L_go144
    s_waitcnt vmcnt(5)
L_go144:
    buffer_load_dwordx4 v[88:91], v12, s[36:39], s84 offen offset:0 nt
    s_bitcmp1_b32 s3, 0
    s_waitcnt vmcnt(6)
    s_cbranch_vccnz L_hi145
    s_waitcnt vmcnt(4)
    s_cbranch_scc1 L_go145
    s_waitcnt vmcnt(3)
L_hi145:
    s_cbranch_scc1 L_go145
    s_waitcnt vmcnt(5)
L_go145:
    buffer_load_dwordx4 v[92:95], v12, s[36:39], s84 offen offset:128 nt
    s_bitcmp1_b32 s3, 0
    s_waitcnt vmcnt(6)
    s_cbranch_vccnz L_hi146
    s_waitcnt vmcnt(4)
    s_cbranch_scc1 L_go146
    s_waitcnt vmcnt(3)
L_hi146:
    s_cbranch_scc1 L_go146
    s_waitcnt vmcnt(5)
L_go146:
    buffer_load_dwordx4 v[96:99], v12, s[36:39], s84 offen offset:256 nt
    v_mov_b32 v13, 0
    v_mov_b32 v14, 4
    ds_max_u32 v13, v14 offset:10796
    v_and_b32 v4, v49, v28
    v_and_b32 v5, v49, v29
    v_and_b32 v6, v49, v30
    v_and_b32 v7, v49, v31
    s_nop 1
    v_mfma_f32_16x16x32_bf16 v[16:19], v[4:7], v[100:103], v[16:19]
    v_mfma_f32_16x16x32_bf16 v[20:23], v[4:7], v[104:107], v[20:23]
    v_mfma_f32_16x16x32_bf16 v[24:27], v[4:7], v[108:111], v[24:27]
    s_addk_i32 s84, 3072
    s_cmp_eq_u32 s84, s34
    s_cselect_b32 s84, 0, s84
    s_sub_u32 s83, s83, 1
    s_cselect_b32 s83, 0, s83
    s_cselect_b32 s3, s31, s2
    s_bitcmp1_b32 s3, 1
    s_cselect_b64 vcc, -1, 0
    s_bitcmp1_b32 s3, 0
    s_waitcnt vmcnt(6)
    s_cbranch_vccnz L_hi147
    s_waitcnt vmcnt(4)
    s_cbranch_scc1 L_go147
    s_waitcnt vmcnt(3)
L_hi147:
    s_cbranch_scc1 L_go147
    s_waitcnt vmcnt(5)
L_go147:
    buffer_load_dwordx4 v[100:103], v12, s[36:39], s84 offen offset:0 nt
    s_bitcmp1_b32 s3, 0
    s_waitcnt vmcnt(6)
    s_cbranch_vccnz L_hi148
    s_waitcnt vmcnt(4)
    s_cbranch_scc1 L_go148
    s_waitcnt vmcnt(3)
L_hi148:
    s_cbranch_scc1 L_go148
    s_waitcnt vmcnt(5)
L_go148:
    buffer_load_dwordx4 v[104:107], v12, s[36:39], s84 offen offset:128 nt
    s_bitcmp1_b32 s3, 0
    s_waitcnt vmcnt(6)
    s_cbranch_vccnz L_hi149
    s_waitcnt vmcnt(4)
    s_cbranch_scc1 L_go149
    s_waitcnt vmcnt(3)
L_hi149:
    s_cbranch_scc1 L_go149
    s_waitcnt vmcnt(5)
L_go149:
    buffer_load_dwordx4 v[108:111], v12, s[36:39], s84 offen offset:256 nt
    v_and_b32 v8, v50, v28
    v_and_b32 v9, v50, v29
    v_and_b32 v10, v50, v30
    v_and_b32 v11, v50, v31
    s_nop 1
    v_mfma_f32_16x16x32_bf16 v[16:19], v[8:11], v[64:67], v[16:19]
    v_mfma_f32_16x16x32_bf16 v[20:23], v[8:11], v[68:71], v[20:23]
    v_mfma_f32_16x16x32_bf16 v[24:27], v[8:11], v[72:75], v[24:27]
    s_addk_i32 s84, 3072
    s_cmp_eq_u32 s84, s34
    s_cselect_b32 s84, 0, s84
    s_sub_u32 s83, s83, 1
    s_cselect_b32 s83, 0, s83
    s_cselect_b32 s3, s31, s2
    s_bitcmp1_b32 s3, 1
    s_cselect_b64 vcc, -1, 0
    s_bitcmp1_b32 s3, 0
    s_waitcnt vmcnt(6)
    s_cbranch_vccnz L_hi150
    s_waitcnt vmcnt(4)
    s_cbranch_scc1 L_go150
    s_waitcnt vmcnt(3)
L_hi150:
    s_cbranch_scc1 L_go150
    s_waitcnt vmcnt(5)
L_go150:
    buffer_load_dwordx4 v[64:67], v12, s[36:39], s84 offen offset:0 nt
    s_bitcmp1_b32 s3, 0
    s_waitcnt vmcnt(6)
    s_cbranch_vccnz L_hi151
    s_waitcnt vmcnt(4)
    s_cbranch_scc1 L_go151
    s_waitcnt vmcnt(3)
L_hi151:
    s_cbranch_scc1 L_go151
    s_waitcnt vmcnt(5)
L_go151:
    buffer_load_dwordx4 v[68:71], v12, s[36:39], s84 offen offset:128 nt
    s_bitcmp1_b32 s3, 0
    s_waitcnt vmcnt(6)
    s_cbranch_vccnz L_hi152
    s_waitcnt vmcnt(4)
    s_cbranch_scc1 L_go152
    s_waitcnt vmcnt(3)
L_hi152:
    s_cbranch_scc1 L_go152
    s_waitcnt vmcnt(5)
L_go152:
    buffer_load_dwordx4 v[72:75], v12, s[36:39], s84 offen offset:256 nt
    v_and_b32 v4, v51, v28
    v_and_b32 v5, v51, v29
    v_and_b32 v6, v51, v30
    v_and_b32 v7, v51, v31
    s_nop 1
    v_mfma_f32_16x16x32_bf16 v[16:19], v[4:7], v[76:79], v[16:19]
    v_mfma_f32_16x16x32_bf16 v[20:23], v[4:7], v[80:83], v[20:23]
    v_mfma_f32_16x16x32_bf16 v[24:27], v[4:7], v[84:87], v[24:27]
    s_addk_i32 s84, 3072
    s_cmp_eq_u32 s84, s34
    s_cselect_b32 s84, 0, s84
    s_sub_u32 s83, s83, 1
    s_cselect_b32 s83, 0, s83
    s_cselect_b32 s3, s31, s2
    s_bitcmp1_b32 s3, 1
    s_cselect_b64 vcc, -1, 0
    s_bitcmp1_b32 s3, 0
    s_waitcnt vmcnt(6)
    s_cbranch_vccnz L_hi153
    s_waitcnt vmcnt(4)
    s_cbranch_scc1 L_go153
    s_waitcnt vmcnt(3)
L_hi153:
    s_cbranch_scc1 L_go153
    s_waitcnt vmcnt(5)
L_go153:
    buffer_load_dwordx4 v[76:79], v12, s[36:39], s84 offen offset:0 nt
    s_bitcmp1_b32 s3, 0
    s_waitcnt vmcnt(6)
    s_cbranch_vccnz L_hi154
    s_waitcnt vmcnt(4)
    s_cbranch_scc1 L_go154
    s_waitcnt vmcnt(3)
L_hi154:
    s_cbranch_scc1 L_go154
    s_waitcnt vmcnt(5)
L_go154:
    buffer_load_dwordx4 v[80:83], v12, s[36:39], s84 offen offset:128 nt
    s_bitcmp1_b32 s3, 0
    s_waitcnt vmcnt(6)
    s_cbranch_vccnz L_hi155
    s_waitcnt vmcnt(4)
    s_cbranch_scc1 L_go155
    s_waitcnt vmcnt(3)
L_hi155:
    s_cbranch_scc1 L_go155
    s_waitcnt vmcnt(5)
L_go155:
    buffer_load_dwordx4 v[84:87], v12, s[36:39], s84 offen offset:256 nt
    v_mov_b32 v13, 0
    ds_read_b32 v13, v13 offset:10836
    s_waitcnt lgkmcnt(0)
    v_readfirstlane_b32 s63, v13
    s_cmp_eq_u32 s63, 0
    s_cselect_b32 s63, 16, s63
    s_cmp_eq_u32 s26, 0
    s_cselect_b32 s64, 4, 0
    s_sub_i32 s63, s63, s64
    s_sub_i32 s64, 16, s63
    s_max_i32 s64, s64, 0
    s_sub_i32 s65, s63, 20
    s_max_i32 s65, s65, 0
    s_cmp_lg_u32 s65, 0
    s_cselect_b32 s66, 1, -1
    s_add_i32 s2, s31, s66
    s_min_u32 s2, s2, 3
    s_add_u32 s64, s64, s65
    s_mul_i32 s83, s64, 2
    s_lshr_b32 s83, s83, 2
    v_and_b32 v8, v52, v28
    v_and_b32 v9, v52, v29
    v_and_b32 v10, v52, v30
    v_and_b32 v11, v52, v31
    s_nop 1
    v_mfma_f32_16x16x32_bf16 v[16:19], v[8:11], v[88:91], v[16:19]
    v_mfma_f32_16x16x32_bf16 v[20:23], v[8:11], v[92:95], v[20:23]
    v_mfma_f32_16x16x32_bf16 v[24:27], v[8:11], v[96:99], v[24:27]
    s_addk_i32 s84, 3072
    s_cmp_eq_u32 s84, s34
    s_cselect_b32 s84, 0, s84
    s_sub_u32 s83, s83, 1
    s_cselect_b32 s83, 0, s83
    s_cselect_b32 s3, s31, s2
    s_bitcmp1_b32 s3, 1
    s_cselect_b64 vcc, -1, 0
    s_bitcmp1_b32 s3, 0
    s_waitcnt vmcnt(6)
    s_cbranch_vccnz L_hi156
    s_waitcnt vmcnt(4)
    s_cbranch_scc1 L_go156
    s_waitcnt vmcnt(3)
L_hi156:
    s_cbranch_scc1 L_go156
    s_waitcnt vmcnt(5)
L_go156:
    buffer_load_dwordx4 v[88:91], v12, s[36:39], s84 offen offset:0 nt
    s_bitcmp1_b32 s3, 0
    s_waitcnt vmcnt(6)
    s_cbranch_vccnz L_hi157
    s_waitcnt vmcnt(4)
    s_cbranch_scc1 L_go157
    s_waitcnt vmcnt(3)
L_hi157:
    s_cbranch_scc1 L_go157
    s_waitcnt vmcnt(5)
L_go157:
    buffer_load_dwordx4 v[92:95], v12, s[36:39], s84 offen offset:128 nt
    s_bitcmp1_b32 s3, 0
    s_waitcnt vmcnt(6)
    s_cbranch_vccnz L_hi158
    s_waitcnt vmcnt(4)
    s_cbranch_scc1 L_go158
    s_waitcnt vmcnt(3)
L_hi158:
    s_cbranch_scc1 L_go158
    s_waitcnt vmcnt(5)
L_go158:
    buffer_load_dwordx4 v[96:99], v12, s[36:39], s84 offen offset:256 nt
    v_and_b32 v4, v53, v28
    v_and_b32 v5, v53, v29
    v_and_b32 v6, v53, v30
    v_and_b32 v7, v53, v31
    s_nop 1
    v_mfma_f32_16x16x32_bf16 v[16:19], v[4:7], v[100:103], v[16:19]
    v_mfma_f32_16x16x32_bf16 v[20:23], v[4:7], v[104:107], v[20:23]
    v_mfma_f32_16x16x32_bf16 v[24:27], v[4:7], v[108:111], v[24:27]
    s_addk_i32 s84, 3072
    s_cmp_eq_u32 s84, s34
    s_cselect_b32 s84, 0, s84
    s_sub_u32 s83, s83, 1
    s_cselect_b32 s83, 0, s83
    s_cselect_b32 s3, s31, s2
    s_bitcmp1_b32 s3, 1
    s_cselect_b64 vcc, -1, 0
    s_bitcmp1_b32 s3, 0
    s_waitcnt vmcnt(6)
    s_cbranch_vccnz L_hi159
    s_waitcnt vmcnt(4)
    s_cbranch_scc1 L_go159
    s_waitcnt vmcnt(3)
L_hi159:
    s_cbranch_scc1 L_go159
    s_waitcnt vmcnt(5)
L_go159:
    buffer_load_dwordx4 v[100:103], v12, s[36:39], s84 offen offset:0 nt
    s_bitcmp1_b32 s3, 0
    s_waitcnt vmcnt(6)
    s_cbranch_vccnz L_hi160
    s_waitcnt vmcnt(4)
    s_cbranch_scc1 L_go160
    s_waitcnt vmcnt(3)
L_hi160:
    s_cbranch_scc1 L_go160
    s_waitcnt vmcnt(5)
L_go160:
    buffer_load_dwordx4 v[104:107], v12, s[36:39], s84 offen offset:128 nt
    s_bitcmp1_b32 s3, 0
    s_waitcnt vmcnt(6)
    s_cbranch_vccnz L_hi161
    s_waitcnt vmcnt(4)
    s_cbranch_scc1 L_go161
    s_waitcnt vmcnt(3)
L_hi161:
    s_cbranch_scc1 L_go161
    s_waitcnt vmcnt(5)
L_go161:
    buffer_load_dwordx4 v[108:111], v12, s[36:39], s84 offen offset:256 nt
    v_mov_b32 v13, 0
    v_mov_b32 v14, 5
    ds_max_u32 v13, v14 offset:10796
    v_and_b32 v8, v54, v28
    v_and_b32 v9, v54, v29
    v_and_b32 v10, v54, v30
    v_and_b32 v11, v54, v31
    s_nop 1
    v_mfma_f32_16x16x32_bf16 v[16:19], v[8:11], v[64:67], v[16:19]
    v_mfma_f32_16x16x32_bf16 v[20:23], v[8:11], v[68:71], v[20:23]
    v_mfma_f32_16x16x32_bf16 v[24:27], v[8:11], v[72:75], v[24:27]
    s_addk_i32 s84, 3072
    s_cmp_eq_u32 s84, s34
    s_cselect_b32 s84, 0, s84
    s_sub_u32 s83, s83, 1
    s_cselect_b32 s83, 0, s83
    s_cselect_b32 s3, s31, s2
    s_bitcmp1_b32 s3, 1
    s_cselect_b64 vcc, -1, 0
    s_bitcmp1_b32 s3, 0
    s_waitcnt vmcnt(6)
    s_cbranch_vccnz L_hi162
    s_waitcnt vmcnt(4)
    s_cbranch_scc1 L_go162
    s_waitcnt vmcnt(3)
L_hi162:
    s_cbranch_scc1 L_go162
    s_waitcnt vmcnt(5)
L_go162:
    buffer_load_dwordx4 v[64:67], v12, s[36:39], s84 offen offset:0 nt
    s_bitcmp1_b32 s3, 0
    s_waitcnt vmcnt(6)
    s_cbranch_vccnz L_hi163
    s_waitcnt vmcnt(4)
    s_cbranch_scc1 L_go163
    s_waitcnt vmcnt(3)
L_hi163:
    s_cbranch_scc1 L_go163
    s_waitcnt vmcnt(5)
L_go163:
    buffer_load_dwordx4 v[68:71], v12, s[36:39], s84 offen offset:128 nt
    s_bitcmp1_b32 s3, 0
    s_waitcnt vmcnt(6)
    s_cbranch_vccnz L_hi164
    s_waitcnt vmcnt(4)
    s_cbranch_scc1 L_go164
    s_waitcnt vmcnt(3)
L_hi164:
    s_cbranch_scc1 L_go164
    s_waitcnt vmcnt(5)
L_go164:
    buffer_load_dwordx4 v[72:75], v12, s[36:39], s84 offen offset:256 nt
    v_and_b32 v4, v55, v28
    v_and_b32 v5, v55, v29
    v_and_b32 v6, v55, v30
    v_and_b32 v7, v55, v31
    s_nop 1
    v_mfma_f32_16x16x32_bf16 v[16:19], v[4:7], v[76:79], v[16:19]
    v_mfma_f32_16x16x32_bf16 v[20:23], v[4:7], v[80:83], v[20:23]
    v_mfma_f32_16x16x32_bf16 v[24:27], v[4:7], v[84:87], v[24:27]
    s_addk_i32 s84, 3072
    s_cmp_eq_u32 s84, s34
    s_cselect_b32 s84, 0, s84
    s_sub_u32 s83, s83, 1
    s_cselect_b32 s83, 0, s83
    s_cselect_b32 s3, s31, s2
    s_bitcmp1_b32 s3, 1
    s_cselect_b64 vcc, -1, 0
    s_bitcmp1_b32 s3, 0
    s_waitcnt vmcnt(6)
    s_cbranch_vccnz L_hi165
    s_waitcnt vmcnt(4)
    s_cbranch_scc1 L_go165
    s_waitcnt vmcnt(3)
L_hi165:
    s_cbranch_scc1 L_go165
    s_waitcnt vmcnt(5)
L_go165:
    buffer_load_dwordx4 v[76:79], v12, s[36:39], s84 offen offset:0 nt
    s_bitcmp1_b32 s3, 0
    s_waitcnt vmcnt(6)
    s_cbranch_vccnz L_hi166
    s_waitcnt vmcnt(4)
    s_cbranch_scc1 L_go166
    s_waitcnt vmcnt(3)
L_hi166:
    s_cbranch_scc1 L_go166
    s_waitcnt vmcnt(5)
L_go166:
    buffer_load_dwordx4 v[80:83], v12, s[36:39], s84 offen offset:128 nt
    s_bitcmp1_b32 s3, 0
    s_waitcnt vmcnt(6)
    s_cbranch_vccnz L_hi167
    s_waitcnt vmcnt(4)
    s_cbranch_scc1 L_go167
    s_waitcnt vmcnt(3)
L_hi167:
    s_cbranch_scc1 L_go167
    s_waitcnt vmcnt(5)
L_go167:
    buffer_load_dwordx4 v[84:87], v12, s[36:39], s84 offen offset:256 nt
    v_and_b32 v8, v56, v28
    v_and_b32 v9, v56, v29
    v_and_b32 v10, v56, v30
    v_and_b32 v11, v56, v31
    s_nop 1
    v_mfma_f32_16x16x32_bf16 v[16:19], v[8:11], v[88:91], v[16:19]
    v_mfma_f32_16x16x32_bf16 v[20:23], v[8:11], v[92:95], v[20:23]
    v_mfma_f32_16x16x32_bf16 v[24:27], v[8:11], v[96:99], v[24:27]
    s_addk_i32 s84, 3072
    s_cmp_eq_u32 s84, s34
    s_cselect_b32 s84, 0, s84
    s_sub_u32 s83, s83, 1
    s_cselect_b32 s83, 0, s83
    s_cselect_b32 s3, s31, s2
    s_bitcmp1_b32 s3, 1
    s_cselect_b64 vcc, -1, 0
    s_bitcmp1_b32 s3, 0
    s_waitcnt vmcnt(6)
    s_cbranch_vccnz L_hi168
    s_waitcnt vmcnt(4)
    s_cbranch_scc1 L_go168
    s_waitcnt vmcnt(3)
L_hi168:
    s_cbranch_scc1 L_go168
    s_waitcnt vmcnt(5)
L_go168:
    buffer_load_dwordx4 v[88:91], v12, s[36:39], s84 offen offset:0 nt
    s_bitcmp1_b32 s3, 0
    s_waitcnt vmcnt(6)
    s_cbranch_vccnz L_hi169
    s_waitcnt vmcnt(4)
    s_cbranch_scc1 L_go169
    s_waitcnt vmcnt(3)
L_hi169:
    s_cbranch_scc1 L_go169
    s_waitcnt vmcnt(5)
L_go169:
    buffer_load_dwordx4 v[92:95], v12, s[36:39], s84 offen offset:128 nt
    s_bitcmp1_b32 s3, 0
    s_waitcnt vmcnt(6)
    s_cbranch_vccnz L_hi170
    s_waitcnt vmcnt(4)
    s_cbranch_scc1 L_go170
    s_waitcnt vmcnt(3)
L_hi170:
    s_cbranch_scc1 L_go170
    s_waitcnt vmcnt(5)
L_go170:
    buffer_load_dwordx4 v[96:99], v12, s[36:39], s84 offen offset:256 nt
    v_mov_b32 v13, 0
    ds_read_b32 v13, v13 offset:10840
    s_waitcnt lgkmcnt(0)
    v_readfirstlane_b32 s63, v13
    s_cmp_eq_u32 s63, 0
    s_cselect_b32 s63, 16, s63
    s_cmp_eq_u32 s26, 0
    s_cselect_b32 s64, 4, 0
    s_sub_i32 s63, s63, s64
    s_sub_i32 s64, 16, s63
    s_max_i32 s64, s64, 0
    s_sub_i32 s65, s63, 20
    s_max_i32 s65, s65, 0
    s_cmp_lg_u32 s65, 0
    s_cselect_b32 s66, 1, -1
    s_add_i32 s2, s31, s66
    s_min_u32 s2, s2, 3
    s_add_u32 s64, s64, s65
    s_mul_i32 s83, s64, 2
    s_lshr_b32 s83, s83, 2
    v_and_b32 v4, v57, v28
    v_and_b32 v5, v57, v29
    v_and_b32 v6, v57, v30
    v_and_b32 v7, v57, v31
    s_nop 1
    v_mfma_f32_16x16x32_bf16 v[16:19], v[4:7], v[100:103], v[16:19]
    v_mfma_f32_16x16x32_bf16 v[20:23], v[4:7], v[104:107], v[20:23]
    v_mfma_f32_16x16x32_bf16 v[24:27], v[4:7], v[108:111], v[24:27]
    s_addk_i32 s84, 3072
    s_cmp_eq_u32 s84, s34
    s_cselect_b32 s84, 0, s84
    s_sub_u32 s83, s83, 1
    s_cselect_b32 s83, 0, s83
    s_cselect_b32 s3, s31, s2
    s_bitcmp1_b32 s3, 1
    s_cselect_b64 vcc, -1, 0
    s_bitcmp1_b32 s3, 0
    s_waitcnt vmcnt(6)
    s_cbranch_vccnz L_hi171
    s_waitcnt vmcnt(4)
    s_cbranch_scc1 L_go171
    s_waitcnt vmcnt(3)
L_hi171:
    s_cbranch_scc1 L_go171
    s_waitcnt vmcnt(5)
L_go171:
    buffer_load_dwordx4 v[100:103], v12, s[36:39], s84 offen offset:0 nt
    s_bitcmp1_b32 s3, 0
    s_waitcnt vmcnt(6)
    s_cbranch_vccnz L_hi172
    s_waitcnt vmcnt(4)
    s_cbranch_scc1 L_go172
    s_waitcnt vmcnt(3)
L_hi172:
    s_cbranch_scc1 L_go172
    s_waitcnt vmcnt(5)
L_go172:
    buffer_load_dwordx4 v[104:107], v12, s[36:39], s84 offen offset:128 nt
    s_bitcmp1_b32 s3, 0
    s_waitcnt vmcnt(6)
    s_cbranch_vccnz L_hi173
    s_waitcnt vmcnt(4)
    s_cbranch_scc1 L_go173
    s_waitcnt vmcnt(3)
L_hi173:
    s_cbranch_scc1 L_go173
    s_waitcnt vmcnt(5)
L_go173:
    buffer_load_dwordx4 v[108:111], v12, s[36:39], s84 offen offset:256 nt
    v_and_b32 v8, v58, v28
    v_and_b32 v9, v58, v29
    v_and_b32 v10, v58, v30
    v_and_b32 v11, v58, v31
    s_nop 1
    v_mfma_f32_16x16x32_bf16 v[16:19], v[8:11], v[64:67], v[16:19]
    v_mfma_f32_16x16x32_bf16 v[20:23], v[8:11], v[68:71], v[20:23]
    v_mfma_f32_16x16x32_bf16 v[24:27], v[8:11], v[72:75], v[24:27]
    s_addk_i32 s84, 3072
    s_cmp_eq_u32 s84, s34
    s_cselect_b32 s84, 0, s84
    s_sub_u32 s83, s83, 1
    s_cselect_b32 s83, 0, s83
    s_cselect_b32 s3, s31, s2
    s_bitcmp1_b32 s3, 1
    s_cselect_b64 vcc, -1, 0
    s_bitcmp1_b32 s3, 0
    s_waitcnt vmcnt(6)
    s_cbranch_vccnz L_hi174
    s_waitcnt vmcnt(4)
    s_cbranch_scc1 L_go174
    s_waitcnt vmcnt(3)
L_hi174:
    s_cbranch_scc1 L_go174
    s_waitcnt vmcnt(5)
L_go174:
    buffer_load_dwordx4 v[64:67], v12, s[36:39], s84 offen offset:0 nt
    s_bitcmp1_b32 s3, 0
    s_waitcnt vmcnt(6)
    s_cbranch_vccnz L_hi175
    s_waitcnt vmcnt(4)
    s_cbranch_scc1 L_go175
    s_waitcnt vmcnt(3)
L_hi175:
    s_cbranch_scc1 L_go175
    s_waitcnt vmcnt(5)
L_go175:
    buffer_load_dwordx4 v[68:71], v12, s[36:39], s84 offen offset:128 nt
    s_bitcmp1_b32 s3, 0
    s_waitcnt vmcnt(6)
    s_cbranch_vccnz L_hi176
    s_waitcnt vmcnt(4)
    s_cbranch_scc1 L_go176
    s_waitcnt vmcnt(3)
L_hi176:
    s_cbranch_scc1 L_go176
    s_waitcnt vmcnt(5)
L_go176:
    buffer_load_dwordx4 v[72:75], v12, s[36:39], s84 offen offset:256 nt
    v_and_b32 v4, v59, v28
    v_and_b32 v5, v59, v29
    v_and_b32 v6, v59, v30
    v_and_b32 v7, v59, v31
    s_nop 1
    v_mfma_f32_16x16x32_bf16 v[16:19], v[4:7], v[76:79], v[16:19]
    v_mfma_f32_16x16x32_bf16 v[20:23], v[4:7], v[80:83], v[20:23]
    v_mfma_f32_16x16x32_bf16 v[24:27], v[4:7], v[84:87], v[24:27]
    s_addk_i32 s84, 3072
    s_cmp_eq_u32 s84, s34
    s_cselect_b32 s84, 0, s84
    s_sub_u32 s83, s83, 1
    s_cselect_b32 s83, 0, s83
    s_cselect_b32 s3, s31, s2
    s_bitcmp1_b32 s3, 1
    s_cselect_b64 vcc, -1, 0
    s_bitcmp1_b32 s3, 0
    s_waitcnt vmcnt(6)
    s_cbranch_vccnz L_hi177
    s_waitcnt vmcnt(4)
    s_cbranch_scc1 L_go177
    s_waitcnt vmcnt(3)
L_hi177:
    s_cbranch_scc1 L_go177
    s_waitcnt vmcnt(5)
L_go177:
    buffer_load_dwordx4 v[76:79], v12, s[36:39], s84 offen offset:0 nt
    s_bitcmp1_b32 s3, 0
    s_waitcnt vmcnt(6)
    s_cbranch_vccnz L_hi178
    s_waitcnt vmcnt(4)
    s_cbranch_scc1 L_go178
    s_waitcnt vmcnt(3)
L_hi178:
    s_cbranch_scc1 L_go178
    s_waitcnt vmcnt(5)
L_go178:
    buffer_load_dwordx4 v[80:83], v12, s[36:39], s84 offen offset:128 nt
    s_bitcmp1_b32 s3, 0
    s_waitcnt vmcnt(6)
    s_cbranch_vccnz L_hi179
    s_waitcnt vmcnt(4)
    s_cbranch_scc1 L_go179
    s_waitcnt vmcnt(3)
L_hi179:
    s_cbranch_scc1 L_go179
    s_waitcnt vmcnt(5)
L_go179:
    buffer_load_dwordx4 v[84:87], v12, s[36:39], s84 offen offset:256 nt
    v_mov_b32 v13, 0
    v_mov_b32 v14, 1
    s_mov_b64 exec, 1
    ds_add_u32 v13, v14 offset:10788
    s_mov_b64 exec, -1
    v_and_b32 v8, v60, v28
    v_and_b32 v9, v60, v29
    v_and_b32 v10, v60, v30
    v_and_b32 v11, v60, v31
    s_nop 1
    v_mfma_f32_16x16x32_bf16 v[16:19], v[8:11], v[88:91], v[16:19]
    v_mfma_f32_16x16x32_bf16 v[20:23], v[8:11], v[92:95], v[20:23]
    v_mfma_f32_16x16x32_bf16 v[24:27], v[8:11], v[96:99], v[24:27]
    v_and_b32 v4, v61, v28
    v_and_b32 v5, v61, v29
    v_and_b32 v6, v61, v30
    v_and_b32 v7, v61, v31
    s_nop 1
    v_mfma_f32_16x16x32_bf16 v[16:19], v[4:7], v[100:103], v[16:19]
    v_mfma_f32_16x16x32_bf16 v[20:23], v[4:7], v[104:107], v[20:23]
    s_waitcnt vmcnt(6)
    v_mfma_f32_16x16x32_bf16 v[24:27], v[4:7], v[108:111], v[24:27]
    v_and_b32 v8, v62, v28
    v_and_b32 v9, v62, v29
    v_and_b32 v10, v62, v30
    v_and_b32 v11, v62, v31
    s_waitcnt vmcnt(5)
    s_nop 0
    v_mfma_f32_16x16x32_bf16 v[16:19], v[8:11], v[64:67], v[16:19]
    s_waitcnt vmcnt(4)
    v_mfma_f32_16x16x32_bf16 v[20:23], v[8:11], v[68:71], v[20:23]
    s_waitcnt vmcnt(3)
    v_mfma_f32_16x16x32_bf16 v[24:27], v[8:11], v[72:75], v[24:27]
    v_and_b32 v4, v63, v28
    v_and_b32 v5, v63, v29
    v_and_b32 v6, v63, v30
    v_and_b32 v7, v63, v31
    s_waitcnt vmcnt(2)
    s_nop 0
    v_mfma_f32_16x16x32_bf16 v[16:19], v[4:7], v[76:79], v[16:19]
    s_waitcnt vmcnt(1)
    v_mfma_f32_16x16x32_bf16 v[20:23], v[4:7], v[80:83], v[20:23]
    s_waitcnt vmcnt(0)
    v_mfma_f32_16x16x32_bf16 v[24:27], v[4:7], v[84:87], v[24:27]
    s_nop 3
    ds_write_b128 v15, v[16:19] offset:10848
    s_nop 0
    ds_write_b128 v15, v[20:23] offset:11872
    s_nop 0
    ds_write_b128 v15, v[24:27] offset:12896
    s_waitcnt lgkmcnt(0)
    s_barrier
    s_cmp_eq_u32 s30, 3
    s_cbranch_scc1 L_noof
    ds_read2st64_b32 v[16:17], v172 offset0:0 offset1:12
    ds_read2st64_b32 v[18:19], v173 offset0:0 offset1:12
    ds_read2st64_b32 v[20:21], v172 offset0:24 offset1:36
    ds_read2st64_b32 v[22:23], v173 offset0:24 offset1:36
    s_waitcnt lgkmcnt(2)
    v_add_f32 v16, v16, v17
    v_add_f32 v18, v18, v19
    s_waitcnt lgkmcnt(0)
    v_add_f32 v20, v20, v21
    v_add_f32 v22, v22, v23
    v_add_f32 v16, v16, v18
    v_add_f32 v20, v20, v22
    v_add_f32 v16, v16, v20
    s_nop 1
    v_mov_b32_dpp v17, v16 quad_perm:[1,0,3,2] row_mask:0xf bank_mask:0xf
    s_mov_b32 exec_lo, 0x55555555
    s_mov_b32 exec_hi, 0x55555555
    v_cvt_pk_bf16_f32 v24, v16, v17
    s_cmp_eq_u32 s82, 1
    s_cbranch_scc0 L_pubo_g
    buffer_store_dword v24, v174, s[48:51], s69 offen offset:0
L_pubo_e:
    s_mov_b64 exec, -1
L_noof:
    s_cmp_lg_u32 s26, 0
    s_cbranch_scc1 L_done
    s_mov_b32 s70, s30
    s_branch L_grp0
L_h123:
    s_sub_u32 s63, s27, 8
    s_cmp_lt_u32 s63, 24
    s_cselect_b32 s64, 1, 0
    s_cmp_eq_u32 s26, 0
    s_cselect_b32 s64, s64, 0
    s_cmp_eq_u32 s64, 0
    s_cbranch_scc1 L_st0_e
    s_mov_b64 s[44:45], s[16:17]
    s_mov_b32 s46, 1966080
    s_mov_b32 s47, 0x20000
    v_mul_u32_u24 v7, 3072, v2
    v_add_u32 v7, v7, v1
    s_mul_i32 s66, s63, 128
    s_add_u32 s67, s65, 0
L_st0:
    s_mul_i32 s68, s67, 196608
    s_add_u32 s68, s68, s66
    buffer_load_dwordx4 v[64:67], v7, s[44:47], s68 offen nt
    s_add_u32 s68, s68, 24576
    buffer_load_dwordx4 v[68:71], v7, s[44:47], s68 offen nt
    s_add_u32 s68, s68, 24576
    buffer_load_dwordx4 v[72:75], v7, s[44:47], s68 offen nt
    s_add_u32 s68, s68, 24576
    buffer_load_dwordx4 v[76:79], v7, s[44:47], s68 offen nt
    s_add_u32 s68, s68, 24576
    s_waitcnt vmcnt(3)
    buffer_load_dwordx4 v[80:83], v7, s[44:47], s68 offen nt
    s_add_u32 s68, s68, 24576
    s_waitcnt vmcnt(3)
    buffer_load_dwordx4 v[84:87], v7, s[44:47], s68 offen nt
    s_add_u32 s68, s68, 24576
    s_waitcnt vmcnt(3)
    buffer_load_dwordx4 v[88:91], v7, s[44:47], s68 offen nt
    s_add_u32 s68, s68, 24576
    s_waitcnt vmcnt(3)
    buffer_load_dwordx4 v[92:95], v7, s[44:47], s68 offen nt
    s_lshl_b32 s68, s67, 13
    s_add_u32 s68, s68, 40672
    v_add_u32 v8, s68, v3
    s_waitcnt vmcnt(0) lgkmcnt(0)
    v_perm_b32 v128, v68, v64, s80
    v_perm_b32 v129, v76, v72, s80
    v_perm_b32 v130, v84, v80, s80
    v_perm_b32 v131, v92, v88, s80
    v_perm_b32 v132, v68, v64, s81
    v_perm_b32 v133, v76, v72, s81
    v_perm_b32 v134, v84, v80, s81
    v_perm_b32 v135, v92, v88, s81
    v_perm_b32 v136, v69, v65, s80
    v_perm_b32 v137, v77, v73, s80
    v_perm_b32 v138, v85, v81, s80
    v_perm_b32 v139, v93, v89, s80
    v_perm_b32 v140, v69, v65, s81
    v_perm_b32 v141, v77, v73, s81
    v_perm_b32 v142, v85, v81, s81
    v_perm_b32 v143, v93, v89, s81
    v_perm_b32 v144, v70, v66, s80
    v_perm_b32 v145, v78, v74, s80
    v_perm_b32 v146, v86, v82, s80
    v_perm_b32 v147, v94, v90, s80
    v_perm_b32 v148, v70, v66, s81
    v_perm_b32 v149, v78, v74, s81
    v_perm_b32 v150, v86, v82, s81
    v_perm_b32 v151, v94, v90, s81
    v_perm_b32 v152, v71, v67, s80
    v_perm_b32 v153, v79, v75, s80
    v_perm_b32 v154, v87, v83, s80
    v_perm_b32 v155, v95, v91, s80
    v_perm_b32 v156, v71, v67, s81
    v_perm_b32 v157, v79, v75, s81
    v_perm_b32 v158, v87, v83, s81
    v_perm_b32 v159, v95, v91, s81
    ds_write_b128 v8, v[128:131] offset:0
    ds_write_b128 v8, v[132:135] offset:1024
    ds_write_b128 v8, v[136:139] offset:2048
    ds_write_b128 v8, v[140:143] offset:3072
    ds_write_b128 v8, v[144:147] offset:4096
    ds_write_b128 v8, v[148:151] offset:5120
    ds_write_b128 v8, v[152:155] offset:6144
    ds_write_b128 v8, v[156:159] offset:7168
    s_add_u32 s67, s67, 3
    s_cmp_lt_u32 s67, 3
    s_cbranch_scc1 L_st0
    s_waitcnt lgkmcnt(0)
L_st0_e:
    s_barrier
    s_cmp_eq_u32 s64, 0
    s_cbranch_scc1 L_st1_e
    s_mov_b64 s[44:45], s[16:17]
    s_mov_b32 s46, 1966080
    s_mov_b32 s47, 0x20000
    v_mul_u32_u24 v7, 3072, v2
    v_add_u32 v7, v7, v1
    s_mul_i32 s66, s63, 128
    s_add_u32 s67, s65, 3
L_st1:
    s_mul_i32 s68, s67, 196608
    s_add_u32 s68, s68, s66
    buffer_load_dwordx4 v[64:67], v7, s[44:47], s68 offen nt
    s_add_u32 s68, s68, 24576
    buffer_load_dwordx4 v[68:71], v7, s[44:47], s68 offen nt
    s_add_u32 s68, s68, 24576
    buffer_load_dwordx4 v[72:75], v7, s[44:47], s68 offen nt
    s_add_u32 s68, s68, 24576
    buffer_load_dwordx4 v[76:79], v7, s[44:47], s68 offen nt
    s_add_u32 s68, s68, 24576
    s_waitcnt vmcnt(3)
    buffer_load_dwordx4 v[80:83], v7, s[44:47], s68 offen nt
    s_add_u32 s68, s68, 24576
    s_waitcnt vmcnt(3)
    buffer_load_dwordx4 v[84:87], v7, s[44:47], s68 offen nt
    s_add_u32 s68, s68, 24576
    s_waitcnt vmcnt(3)
    buffer_load_dwordx4 v[88:91], v7, s[44:47], s68 offen nt
    s_add_u32 s68, s68, 24576
    s_waitcnt vmcnt(3)
    buffer_load_dwordx4 v[92:95], v7, s[44:47], s68 offen nt
    s_lshl_b32 s68, s67, 13
    s_add_u32 s68, s68, 40672
    v_add_u32 v8, s68, v3
    s_waitcnt vmcnt(0) lgkmcnt(0)
    v_perm_b32 v128, v68, v64, s80
    v_perm_b32 v129, v76, v72, s80
    v_perm_b32 v130, v84, v80, s80
    v_perm_b32 v131, v92, v88, s80
    v_perm_b32 v132, v68, v64, s81
    v_perm_b32 v133, v76, v72, s81
    v_perm_b32 v134, v84, v80, s81
    v_perm_b32 v135, v92, v88, s81
    v_perm_b32 v136, v69, v65, s80
    v_perm_b32 v137, v77, v73, s80
    v_perm_b32 v138, v85, v81, s80
    v_perm_b32 v139, v93, v89, s80
    v_perm_b32 v140, v69, v65, s81
    v_perm_b32 v141, v77, v73, s81
    v_perm_b32 v142, v85, v81, s81
    v_perm_b32 v143, v93, v89, s81
    v_perm_b32 v144, v70, v66, s80
    v_perm_b32 v145, v78, v74, s80
    v_perm_b32 v146, v86, v82, s80
    v_perm_b32 v147, v94, v90, s80
    v_perm_b32 v148, v70, v66, s81
    v_perm_b32 v149, v78, v74, s81
    v_perm_b32 v150, v86, v82, s81
    v_perm_b32 v151, v94, v90, s81
    v_perm_b32 v152, v71, v67, s80
    v_perm_b32 v153, v79, v75, s80
    v_perm_b32 v154, v87, v83, s80
    v_perm_b32 v155, v95, v91, s80
    v_perm_b32 v156, v71, v67, s81
    v_perm_b32 v157, v79, v75, s81
    v_perm_b32 v158, v87, v83, s81
    v_perm_b32 v159, v95, v91, s81
    ds_write_b128 v8, v[128:131] offset:0
    ds_write_b128 v8, v[132:135] offset:1024
    ds_write_b128 v8, v[136:139] offset:2048
    ds_write_b128 v8, v[140:143] offset:3072
    ds_write_b128 v8, v[144:147] offset:4096
    ds_write_b128 v8, v[148:151] offset:5120
    ds_write_b128 v8, v[152:155] offset:6144
    ds_write_b128 v8, v[156:159] offset:7168
    s_add_u32 s67, s67, 3
    s_cmp_lt_u32 s67, 10
    s_cbranch_scc1 L_st1
    s_waitcnt lgkmcnt(0)
L_st1_e:
    s_barrier
    v_mov_b32 v13, 0
    ds_read_b32 v16, v13 offset:10784
    s_lshl_b32 s60, s30, 10
    s_add_u32 s60, s60, 40672
    v_add_u32 v4, s60, v3
    v_add_u32 v5, 0x10000, v4
    ds_read_b128 v[176:179], v4 offset:0
    ds_read_b128 v[180:183], v4 offset:8192
    ds_read_b128 v[184:187], v4 offset:16384
    ds_read_b128 v[188:191], v4 offset:24576
    ds_read_b128 v[192:195], v4 offset:32768
    ds_read_b128 v[196:199], v4 offset:40960
    ds_read_b128 v[200:203], v4 offset:49152
    ds_read_b128 v[204:207], v4 offset:57344
    ds_read_b128 v[208:211], v5 offset:0
    ds_read_b128 v[212:215], v5 offset:8192
    s_waitcnt lgkmcnt(0)
    v_readfirstlane_b32 s82, v16
    s_barrier
    s_cmp_eq_u32 s64, 0
    s_cbranch_scc1 L_st2_e
    s_mov_b64 s[44:45], s[18:19]
    s_mov_b32 s46, 1966080
    s_mov_b32 s47, 0x20000
    v_mul_u32_u24 v7, 1280, v2
    v_add_u32 v7, v7, v1
    s_mul_i32 s66, s63, 81920
    s_add_u32 s67, s65, 0
    v_bfe_u32 v9, v0, 2, 1
    v_lshlrev_b32 v9, 11, v9
    v_bfe_u32 v10, v0, 3, 1
    v_lshl_add_u32 v9, v10, 10, v9
    v_lshrrev_b32 v10, 4, v0
    v_lshl_add_u32 v9, v10, 8, v9
    v_and_b32 v10, 3, v0
    v_lshl_add_u32 v9, v10, 6, v9
L_st2:
    s_mul_i32 s68, s67, 128
    s_add_u32 s68, s68, s66
    buffer_load_dwordx4 v[64:67], v7, s[44:47], s68 offen nt
    s_add_u32 s68, s68, 10240
    buffer_load_dwordx4 v[68:71], v7, s[44:47], s68 offen nt
    s_add_u32 s68, s68, 10240
    buffer_load_dwordx4 v[72:75], v7, s[44:47], s68 offen nt
    s_add_u32 s68, s68, 10240
    buffer_load_dwordx4 v[76:79], v7, s[44:47], s68 offen nt
    s_add_u32 s68, s68, 10240
    s_waitcnt vmcnt(3)
    buffer_load_dwordx4 v[80:83], v7, s[44:47], s68 offen nt
    s_add_u32 s68, s68, 10240
    s_waitcnt vmcnt(3)
    buffer_load_dwordx4 v[84:87], v7, s[44:47], s68 offen nt
    s_add_u32 s68, s68, 10240
    s_waitcnt vmcnt(3)
    buffer_load_dwordx4 v[88:91], v7, s[44:47], s68 offen nt
    s_add_u32 s68, s68, 10240
    s_waitcnt vmcnt(3)
    buffer_load_dwordx4 v[92:95], v7, s[44:47], s68 offen nt
    s_lshl_b32 s68, s67, 13
    s_add_u32 s68, s68, 40672
    v_add_u32 v8, s68, v9
    s_waitcnt vmcnt(0) lgkmcnt(0)
    v_perm_b32 v128, v68, v64, s80
    v_perm_b32 v129, v76, v72, s80
    v_perm_b32 v130, v84, v80, s80
    v_perm_b32 v131, v92, v88, s80
    v_perm_b32 v132, v68, v64, s81
    v_perm_b32 v133, v76, v72, s81
    v_perm_b32 v134, v84, v80, s81
    v_perm_b32 v135, v92, v88, s81
    v_perm_b32 v136, v69, v65, s80
    v_perm_b32 v137, v77, v73, s80
    v_perm_b32 v138, v85, v81, s80
    v_perm_b32 v139, v93, v89, s80
    v_perm_b32 v140, v69, v65, s81
    v_perm_b32 v141, v77, v73, s81
    v_perm_b32 v142, v85, v81, s81
    v_perm_b32 v143, v93, v89, s81
    v_perm_b32 v144, v70, v66, s80
    v_perm_b32 v145, v78, v74, s80
    v_perm_b32 v146, v86, v82, s80
    v_perm_b32 v147, v94, v90, s80
    v_perm_b32 v148, v70, v66, s81
    v_perm_b32 v149, v78, v74, s81
    v_perm_b32 v150, v86, v82, s81
    v_perm_b32 v151, v94, v90, s81
    v_perm_b32 v152, v71, v67, s80
    v_perm_b32 v153, v79, v75, s80
    v_perm_b32 v154, v87, v83, s80
    v_perm_b32 v155, v95, v91, s80
    v_perm_b32 v156, v71, v67, s81
    v_perm_b32 v157, v79, v75, s81
    v_perm_b32 v158, v87, v83, s81
    v_perm_b32 v159, v95, v91, s81
    ds_write_b128 v8, v[128:131] offset:0
    ds_write_b128 v8, v[132:135] offset:16
    ds_write_b128 v8, v[136:139] offset:32
    ds_write_b128 v8, v[140:143] offset:48
    ds_write_b128 v8, v[144:147] offset:4096
    ds_write_b128 v8, v[148:151] offset:4112
    ds_write_b128 v8, v[152:155] offset:4128
    ds_write_b128 v8, v[156:159] offset:4144
    s_add_u32 s67, s67, 3
    s_cmp_lt_u32 s67, 10
    s_cbranch_scc1 L_st2
    s_waitcnt lgkmcnt(0)
L_st2_e:
    s_cmp_lg_u32 s30, 6
    s_cbranch_scc1 L_b5
L_wo:
    s_mov_b64 s[44:45], s[12:13]
    s_mov_b32 s46, 7864320
    s_mov_b32 s47, 0x20000
    s_cmp_ge_u32 s27, 30
    s_cselect_b32 s46, 0, s46
    s_bfe_u32 s62, s30, 0x10001
    s_mul_i32 s63, s27, 26
    s_lshr_b32 s63, s63, 8
    s_mul_i32 s64, s63, 10
    s_sub_u32 s64, s27, s64
    s_mul_i32 s66, s26, 3
    s_add_u32 s63, s63, s66
    s_lshl1_add_u32 s66, s63, s62
    s_mul_i32 s66, s66, 163840
    s_lshl_b32 s67, s64, 7
    s_add_u32 s66, s66, s67
    v_mul_u32_u24 v15, 10240, v2
    v_add_u32 v15, v15, v1
    s_lshl_b32 s67, s62, 13
    s_add_u32 s67, s67, 24288
    v_add_u32 v12, s67, v3
    v_xor_b32 v7, 0, v3
    s_xor_b32 s67, s62, 1
    s_lshl_b32 s67, s67, 13
    s_add_u32 s67, s67, 24288
    v_add_u32 v7, s67, v7
    s_lshl_b32 s68, s63, 12
    s_lshl_b32 s67, s62, 11
    s_add_u32 s72, s68, s67
    s_xor_b32 s67, s67, 2048
    s_add_u32 s73, s68, s67
    s_mul_i32 s67, s63, 20608
    s_lshl_b32 s68, s64, 11
    s_add_u32 s67, s67, s68
    s_lshl_b32 s68, s62, 10
    s_add_u32 s67, s67, s68
    s_add_u32 s67, s67, 98304
    s_mov_b32 s70, 7
    v_mov_b32 v10, 0
    v_mov_b32 v11, 1
    s_add_u32 s68, s66, 0
    buffer_load_dwordx4 v[64:67], v15, s[44:47], s68 offen offset:0 nt
    buffer_load_dwordx4 v[68:71], v15, s[44:47], s68 offen offset:1280 nt
    buffer_load_dwordx4 v[72:75], v15, s[44:47], s68 offen offset:2560 nt
    buffer_load_dwordx4 v[76:79], v15, s[44:47], s68 offen offset:3840 nt
    s_add_u32 s68, s66, 5120
    buffer_load_dwordx4 v[80:83], v15, s[44:47], s68 offen offset:0 nt
    buffer_load_dwordx4 v[84:87], v15, s[44:47], s68 offen offset:1280 nt
    buffer_load_dwordx4 v[88:91], v15, s[44:47], s68 offen offset:2560 nt
    buffer_load_dwordx4 v[92:95], v15, s[44:47], s68 offen offset:3840 nt
    s_waitcnt vmcnt(0)
    v_perm_b32 v128, v68, v64, s80
    v_perm_b32 v129, v76, v72, s80
    v_perm_b32 v130, v84, v80, s80
    v_perm_b32 v131, v92, v88, s80
    v_perm_b32 v132, v68, v64, s81
    v_perm_b32 v133, v76, v72, s81
    v_perm_b32 v134, v84, v80, s81
    v_perm_b32 v135, v92, v88, s81
    v_perm_b32 v136, v69, v65, s80
    v_perm_b32 v137, v77, v73, s80
    v_perm_b32 v138, v85, v81, s80
    v_perm_b32 v139, v93, v89, s80
    v_perm_b32 v140, v69, v65, s81
    v_perm_b32 v141, v77, v73, s81
    v_perm_b32 v142, v85, v81, s81
    v_perm_b32 v143, v93, v89, s81
    v_perm_b32 v144, v70, v66, s80
    v_perm_b32 v145, v78, v74, s80
    v_perm_b32 v146, v86, v82, s80
    v_perm_b32 v147, v94, v90, s80
    v_perm_b32 v148, v70, v66, s81
    v_perm_b32 v149, v78, v74, s81
    v_perm_b32 v150, v86, v82, s81
    v_perm_b32 v151, v94, v90, s81
    v_perm_b32 v152, v71, v67, s80
    v_perm_b32 v153, v79, v75, s80
    v_perm_b32 v154, v87, v83, s80
    v_perm_b32 v155, v95, v91, s80
    v_perm_b32 v156, v71, v67, s81
    v_perm_b32 v157, v79, v75, s81
    v_perm_b32 v158, v87, v83, s81
    v_perm_b32 v159, v95, v91, s81
    v_mov_b32 v13, 0
    s_mov_b32 s85, 1600000
L_vprogx:
    s_sleep 2
    ds_read_b32 v14, v13 offset:10788
    s_sub_u32 s85, s85, 1
    s_waitcnt lgkmcnt(0)
    s_cbranch_scc1 L_vprogx_x
    v_cmp_gt_u32 vcc, 4, v14
    s_cbranch_vccnz L_vprogx
L_vprogx_x:
    s_add_u32 s68, s66, 81920
    buffer_load_dwordx4 v[96:99], v15, s[44:47], s68 offen offset:0 nt
    buffer_load_dwordx4 v[100:103], v15, s[44:47], s68 offen offset:1280 nt
    buffer_load_dwordx4 v[104:107], v15, s[44:47], s68 offen offset:2560 nt
    buffer_load_dwordx4 v[108:111], v15, s[44:47], s68 offen offset:3840 nt
    s_add_u32 s68, s66, 87040
    buffer_load_dwordx4 v[112:115], v15, s[44:47], s68 offen offset:0 nt
    buffer_load_dwordx4 v[116:119], v15, s[44:47], s68 offen offset:1280 nt
    buffer_load_dwordx4 v[120:123], v15, s[44:47], s68 offen offset:2560 nt
    buffer_load_dwordx4 v[124:127], v15, s[44:47], s68 offen offset:3840 nt
    s_barrier
    s_cmp_ge_u32 s27, 30
    s_cbranch_scc1 L_odone
    s_waitcnt vmcnt(8)
    buffer_load_dwordx4 v[32:35], v3, s[48:51], s72 offen offset:0 sc1
    buffer_load_dwordx4 v[36:39], v3, s[48:51], s72 offen offset:1024 sc1
    s_waitcnt vmcnt(2)
    v_perm_b32 v216, v100, v96, s80
    v_perm_b32 v217, v108, v104, s80
    v_perm_b32 v218, v116, v112, s80
    v_perm_b32 v219, v124, v120, s80
    v_perm_b32 v220, v100, v96, s81
    v_perm_b32 v221, v108, v104, s81
    v_perm_b32 v222, v116, v112, s81
    v_perm_b32 v223, v124, v120, s81
    v_perm_b32 v224, v101, v97, s80
    v_perm_b32 v225, v109, v105, s80
    v_perm_b32 v226, v117, v113, s80
    v_perm_b32 v227, v125, v121, s80
    v_perm_b32 v228, v101, v97, s81
    v_perm_b32 v229, v109, v105, s81
    v_perm_b32 v230, v117, v113, s81
    v_perm_b32 v231, v125, v121, s81
    v_perm_b32 v232, v102, v98, s80
    v_perm_b32 v233, v110, v106, s80
    v_perm_b32 v234, v118, v114, s80
    v_perm_b32 v235, v126, v122, s80
    v_perm_b32 v236, v102, v98, s81
    v_perm_b32 v237, v110, v106, s81
    v_perm_b32 v238, v118, v114, s81
    v_perm_b32 v239, v126, v122, s81
    v_perm_b32 v240, v103, v99, s80
    v_perm_b32 v241, v111, v107, s80
    v_perm_b32 v242, v119, v115, s80
    v_perm_b32 v243, v127, v123, s80
    v_perm_b32 v244, v103, v99, s81
    v_perm_b32 v245, v111, v107, s81
    v_perm_b32 v246, v119, v115, s81
    v_perm_b32 v247, v127, v123, s81
    s_mov_b32 s85, 100000
    s_branch L_po_c
L_po:
    s_mov_b64 exec, s[4:5]
    buffer_load_dwordx4 v[32:35], v3, s[48:51], s72 offen offset:0 sc1
    s_mov_b64 exec, s[6:7]
    buffer_load_dwordx4 v[36:39], v3, s[48:51], s72 offen offset:1024 sc1
    s_mov_b64 exec, -1
L_po_c:
    s_sub_u32 s85, s85, 1
    s_cbranch_scc1 L_po_t
    s_waitcnt vmcnt(1)
    v_max3_u32 v4, v32, v33, v34
    v_max_u32 v4, v4, v35
    v_cmp_eq_u32 s[4:5], -1, v4
    s_waitcnt vmcnt(0)
    v_max3_u32 v4, v36, v37, v38
    v_max_u32 v4, v4, v39
    v_cmp_eq_u32 s[6:7], -1, v4
    s_or_b64 vcc, s[4:5], s[6:7]
    s_cbranch_scc1 L_po
L_po_x:
    s_cmp_eq_u32 s62, 0
    s_cbranch_scc0 L_wo1
    v_mfma_f32_16x16x32_bf16 v[64:67], v[32:35], v[144:147], 0
    v_mfma_f32_16x16x32_bf16 v[64:67], v[36:39], v[232:235], v[64:67]
    v_mfma_f32_16x16x32_bf16 v[68:71], v[32:35], v[148:151], 0
    v_mfma_f32_16x16x32_bf16 v[68:71], v[36:39], v[236:239], v[68:71]
    v_mfma_f32_16x16x32_bf16 v[72:75], v[32:35], v[152:155], 0
    v_mfma_f32_16x16x32_bf16 v[72:75], v[36:39], v[240:243], v[72:75]
    v_mfma_f32_16x16x32_bf16 v[76:79], v[32:35], v[156:159], 0
    v_mfma_f32_16x16x32_bf16 v[76:79], v[36:39], v[244:247], v[76:79]
    v_mfma_f32_16x16x32_bf16 v[80:83], v[32:35], v[128:131], 0
    v_mfma_f32_16x16x32_bf16 v[80:83], v[36:39], v[216:219], v[80:83]
    v_permlane32_swap_b32 v64, v66
    v_permlane32_swap_b32 v65, v67
    v_mfma_f32_16x16x32_bf16 v[84:87], v[32:35], v[132:135], 0
    v_permlane32_swap_b32 v68, v70
    v_permlane32_swap_b32 v69, v71
    v_mfma_f32_16x16x32_bf16 v[84:87], v[36:39], v[220:223], v[84:87]
    v_permlane32_swap_b32 v72, v74
    v_permlane32_swap_b32 v73, v75
    v_mfma_f32_16x16x32_bf16 v[88:91], v[32:35], v[136:139], 0
    v_permlane32_swap_b32 v76, v78
    v_permlane32_swap_b32 v77, v79
    v_mfma_f32_16x16x32_bf16 v[88:91], v[36:39], v[224:227], v[88:91]
    v_add_f32_dpp v44, v66, v64 row_ror:8 row_mask:0xf bank_mask:0x3
    v_add_f32_dpp v45, v70, v68 row_ror:8 row_mask:0xf bank_mask:0x3
    v_add_f32_dpp v46, v74, v72 row_ror:8 row_mask:0xf bank_mask:0x3
    v_mfma_f32_16x16x32_bf16 v[92:95], v[32:35], v[140:143], 0
    v_add_f32_dpp v47, v78, v76 row_ror:8 row_mask:0xf bank_mask:0x3
    v_add_f32_dpp v44, v65, v67 row_ror:8 row_mask:0xf bank_mask:0xc
    v_add_f32_dpp v45, v69, v71 row_ror:8 row_mask:0xf bank_mask:0xc
    v_mfma_f32_16x16x32_bf16 v[92:95], v[36:39], v[228:231], v[92:95]
    v_add_f32_dpp v46, v73, v75 row_ror:8 row_mask:0xf bank_mask:0xc
    v_add_f32_dpp v47, v77, v79 row_ror:8 row_mask:0xf bank_mask:0xc
    s_branch L_wo2
L_wo1:
    v_mfma_f32_16x16x32_bf16 v[64:67], v[32:35], v[128:131], 0
    v_mfma_f32_16x16x32_bf16 v[64:67], v[36:39], v[216:219], v[64:67]
    v_mfma_f32_16x16x32_bf16 v[68:71], v[32:35], v[132:135], 0
    v_mfma_f32_16x16x32_bf16 v[68:71], v[36:39], v[220:223], v[68:71]
    v_mfma_f32_16x16x32_bf16 v[72:75], v[32:35], v[136:139], 0
    v_mfma_f32_16x16x32_bf16 v[72:75], v[36:39], v[224:227], v[72:75]
    v_mfma_f32_16x16x32_bf16 v[76:79], v[32:35], v[140:143], 0
    v_mfma_f32_16x16x32_bf16 v[76:79], v[36:39], v[228:231], v[76:79]
    v_mfma_f32_16x16x32_bf16 v[80:83], v[32:35], v[144:147], 0
    v_mfma_f32_16x16x32_bf16 v[80:83], v[36:39], v[232:235], v[80:83]
    v_permlane32_swap_b32 v64, v66
    v_permlane32_swap_b32 v65, v67
    v_mfma_f32_16x16x32_bf16 v[84:87], v[32:35], v[148:151], 0
    v_permlane32_swap_b32 v68, v70
    v_permlane32_swap_b32 v69, v71
    v_mfma_f32_16x16x32_bf16 v[84:87], v[36:39], v[236:239], v[84:87]
    v_permlane32_swap_b32 v72, v74
    v_permlane32_swap_b32 v73, v75
    v_mfma_f32_16x16x32_bf16 v[88:91], v[32:35], v[152:155], 0
    v_permlane32_swap_b32 v76, v78
    v_permlane32_swap_b32 v77, v79
    v_mfma_f32_16x16x32_bf16 v[88:91], v[36:39], v[240:243], v[88:91]
    v_add_f32_dpp v44, v66, v64 row_ror:8 row_mask:0xf bank_mask:0x3
    v_add_f32_dpp v45, v70, v68 row_ror:8 row_mask:0xf bank_mask:0x3
    v_add_f32_dpp v46, v74, v72 row_ror:8 row_mask:0xf bank_mask:0x3
    v_mfma_f32_16x16x32_bf16 v[92:95], v[32:35], v[156:159], 0
    v_add_f32_dpp v47, v78, v76 row_ror:8 row_mask:0xf bank_mask:0x3
    v_add_f32_dpp v44, v65, v67 row_ror:8 row_mask:0xf bank_mask:0xc
    v_add_f32_dpp v45, v69, v71 row_ror:8 row_mask:0xf bank_mask:0xc
    v_mfma_f32_16x16x32_bf16 v[92:95], v[36:39], v[244:247], v[92:95]
    v_add_f32_dpp v46, v73, v75 row_ror:8 row_mask:0xf bank_mask:0xc
    v_add_f32_dpp v47, v77, v79 row_ror:8 row_mask:0xf bank_mask:0xc
L_wo2:
    ds_write_b128 v12, v[44:47]
    s_mov_b64 exec, 1
    ds_add_u32 v10, v11 offset:10812
    s_mov_b64 exec, -1
    v_permlane32_swap_b32 v80, v82
    v_permlane32_swap_b32 v81, v83
    v_permlane32_swap_b32 v84, v86
    v_permlane32_swap_b32 v85, v87
    v_permlane32_swap_b32 v88, v90
    v_permlane32_swap_b32 v89, v91
    v_permlane32_swap_b32 v92, v94
    v_permlane32_swap_b32 v93, v95
    v_add_f32_dpp v48, v82, v80 row_ror:8 row_mask:0xf bank_mask:0x3
    v_add_f32_dpp v49, v86, v84 row_ror:8 row_mask:0xf bank_mask:0x3
    v_add_f32_dpp v50, v90, v88 row_ror:8 row_mask:0xf bank_mask:0x3
    v_add_f32_dpp v51, v94, v92 row_ror:8 row_mask:0xf bank_mask:0x3
    v_add_f32_dpp v48, v81, v83 row_ror:8 row_mask:0xf bank_mask:0xc
    v_add_f32_dpp v49, v85, v87 row_ror:8 row_mask:0xf bank_mask:0xc
    v_add_f32_dpp v50, v89, v91 row_ror:8 row_mask:0xf bank_mask:0xc
    v_add_f32_dpp v51, v93, v95 row_ror:8 row_mask:0xf bank_mask:0xc
    s_mov_b32 s85, 1600000
L_wx:
    ds_read_b32 v14, v10 offset:10812
    ds_read_b128 v[52:55], v7
    s_sub_u32 s85, s85, 1
    s_waitcnt lgkmcnt(0)
    s_cbranch_scc1 L_wx_x
    v_cmp_gt_u32 vcc, 2, v14
    s_cbranch_vccnz L_wx
L_wx_x:
    v_add_f32 v48, v48, v52
    v_add_f32 v49, v49, v53
    v_add_f32 v50, v50, v54
    v_add_f32 v51, v51, v55
    s_cmp_eq_u32 s26, 0
    s_cbranch_scc1 L_yloc
L_yglob:
    buffer_store_dwordx4 v[48:51], v3, s[48:51], s67 offen sc1
    s_branch L_odone
L_yloc:
    s_cmp_eq_u32 s82, 1
    s_cbranch_scc0 L_yglob
    buffer_store_dwordx4 v[48:51], v3, s[48:51], s67 offen
    s_branch L_odone
L_b5:
    s_barrier
    s_cmp_eq_u32 s30, 7
    s_cselect_b32 s70, 4, 7
    s_branch L_odone
L_odone:
    s_cmp_lg_u32 s26, 0
    s_cbranch_scc1 L_done
L_grp0:
    s_and_b32 s60, s30, 5
    s_cmp_eq_u32 s60, 4
    s_cbranch_scc0 L_prep
    s_barrier
    s_mov_b32 s70, 8
L_prep:
    s_sub_u32 s71, s27, 8
    s_lshr_b32 s61, s30, 2
    s_and_b32 s62, s30, 3
    s_lshl_b32 s63, s61, 1
    s_xor_b32 s62, s62, s63
    s_mul_i32 s76, s62, 3
    s_cmp_eq_u32 s62, 3
    s_cselect_b32 s76, 8, s76
    s_cmp_lt_u32 s62, 2
    s_cselect_b32 s77, 1, 0
    s_lshl_b32 s63, s76, 13
    s_lshl_b32 s64, s61, 12
    s_add_u32 s63, s63, s64
    s_add_u32 s63, s63, 40672
    v_add_u32 v4, s63, v3
    ds_read_b128 v[216:219], v4 offset:0
    ds_read_b128 v[220:223], v4 offset:1024
    ds_read_b128 v[224:227], v4 offset:2048
    ds_read_b128 v[228:231], v4 offset:3072
    ds_read_b128 v[232:235], v4 offset:8192
    ds_read_b128 v[236:239], v4 offset:9216
    ds_read_b128 v[240:243], v4 offset:10240
    ds_read_b128 v[244:247], v4 offset:11264
    s_cmp_eq_u32 s77, 0
    s_cbranch_scc1 L_no3a
    ds_read_b128 v[160:163], v4 offset:16384
    ds_read_b128 v[164:167], v4 offset:17408
    ds_read_b128 v[168:171], v4 offset:18432
    ds_read_b128 v[172:175], v4 offset:19456
L_no3a:
    s_mul_i32 s62, s71, 20608
    s_lshl_b32 s76, s76, 11
    s_add_u32 s76, s76, s62
    s_lshl_b32 s61, s61, 10
    s_add_u32 s76, s76, s61
    s_add_u32 s76, s76, 613376
    s_add_u32 s68, s76, 4096
    s_mov_b64 s[56:57], s[20:21]
    s_mov_b32 s58, 10240
    s_mov_b32 s59, 0x20000
    v_lshrrev_b32 v6, 3, v0
    v_mul_u32_u24 v15, 20608, v6
    v_add_u32 v15, v15, v1
    s_mul_i32 s69, s30, 2560
    s_add_u32 s69, s69, 592896
    v_lshlrev_b32 v8, 3, v0
    v_bfe_u32 v10, v0, 2, 1
    v_bfe_u32 v11, v0, 3, 1
    v_lshl_add_u32 v10, v10, 1, v11
    v_xor_b32 v11, s30, v10
    v_lshlrev_b32 v11, 5, v11
    v_lshl_add_u32 v10, v10, 8, v11
    v_and_b32 v11, 3, v0
    v_lshl_add_u32 v10, v11, 3, v10
    v_lshrrev_b32 v11, 4, v0
    v_lshl_add_u32 v10, v11, 10, v10
    v_bfe_u32 v11, v0, 3, 1
    v_bfe_u32 v16, v0, 4, 1
    v_lshl_add_u32 v11, v11, 1, v16
    v_xor_b32 v16, s30, v11
    v_lshlrev_b32 v16, 5, v16
    v_lshl_add_u32 v11, v11, 8, v16
    v_and_b32 v16, 7, v0
    v_lshl_add_u32 v11, v16, 2, v11
    v_lshrrev_b32 v16, 5, v0
    v_lshl_add_u32 v11, v16, 10, v11
    v_lshrrev_b32 v5, 5, v0
    v_bfe_u32 v16, v0, 3, 1
    v_lshl_add_u32 v5, v5, 1, v16
    v_and_b32 v16, 7, v0
    v_mul_u32_u24 v7, 144, v16
    v_and_b32 v18, 48, v0
    v_add_u32 v7, v7, v18
    v_mov_b32 v120, 0
    v_mov_b32 v121, 0
    v_mov_b32 v122, 0
    v_mov_b32 v123, 0
    v_mov_b32 v124, 0
    v_mov_b32 v125, 0
    v_mov_b32 v126, 0
    v_mov_b32 v127, 0
    v_mov_b32 v128, 0
    v_mov_b32 v129, 0
    v_mov_b32 v130, 0
    v_mov_b32 v131, 0
    v_mov_b32 v132, 0
    v_mov_b32 v133, 0
    v_mov_b32 v134, 0
    v_mov_b32 v135, 0
    v_xor_b32 v16, v16, v5
    v_lshlrev_b32 v16, 5, v16
    v_lshl_add_u32 v5, v5, 8, v16
    v_and_b32 v16, 16, v0
    v_add_u32 v5, v5, v16
    v_bfe_u32 v16, v0, 4, 1
    v_lshrrev_b32 v17, 5, v0
    v_lshlrev_b32 v16, 2, v16
    v_lshl_add_u32 v16, v17, 1, v16
    v_bfe_u32 v17, v0, 3, 1
    v_add_u32 v16, v16, v17
    v_mul_u32_u24 v16, 144, v16
    v_lshrrev_b32 v17, 3, v1
    s_lshl_b32 s61, s30, 4
    v_add3_u32 v16, v16, v17, s61
    s_mul_i32 s60, s27, 5
    s_add_u32 s60, s60, s70
    s_lshr_b32 s61, s60, 3
    s_and_b32 s62, s60, 7
    s_and_b32 s63, s62, 1
    s_and_b32 s64, s62, 2
    s_lshl1_add_u32 s63, s64, s63
    s_lshr_b32 s64, s62, 1
    s_and_b32 s64, s64, 2
    s_add_u32 s63, s63, s64
    s_lshl_b32 s72, s60, 7
    s_add_u32 s72, s72, 98304
    s_add_u32 s73, s72, 164864
    s_add_u32 s74, s72, 329728
    s_mul_i32 s64, s63, 1280
    s_lshr_b32 s65, s61, 1
    s_lshl_b32 s65, s65, 7
    s_add_u32 s64, s64, s65
    s_and_b32 s65, s61, 1
    s_lshl3_add_u32 s64, s65, s64
    v_lshrrev_b32 v9, 4, v0
    v_lshl_add_u32 v12, v9, 1, v1
    v_add_u32 v12, s64, v12
    v_lshlrev_b32 v9, 5, v9
    v_lshrrev_b32 v17, 2, v1
    v_add_u32 v9, v9, v17
    s_and_b32 s64, s60, 1
    s_bfe_u32 s66, s60, 0x20001
    s_lshl2_add_u32 s64, s64, s66
    s_lshr_b32 s66, s61, 1
    s_lshl_b32 s66, s66, 7
    s_lshl4_add_u32 s66, s64, s66
    s_lshl3_add_u32 s66, s65, s66
    v_and_b32 v17, 7, v0
    v_mul_u32_u24 v18, 1280, v17
    v_lshrrev_b32 v19, 4, v0
    v_lshl_add_u32 v18, v19, 1, v18
    v_add_u32 v18, s66, v18
    s_lshl_b32 s66, s61, 7
    s_lshl2_add_u32 s66, s64, s66
    s_add_u32 s66, s66, 592896
    v_mul_u32_u24 v17, 2560, v17
    v_lshl_add_u32 v19, v19, 5, v17
    v_add_u32 v19, s66, v19
    s_mul_i32 s75, s63, 2560
    s_lshl_b32 s65, s61, 7
    s_add_u32 s75, s75, s65
    s_add_u32 s75, s75, 592896
    buffer_load_dwordx4 v[40:43], v3, s[48:51], s69 offen
    buffer_load_dwordx4 v[44:47], v3, s[48:51], s69 offen offset:1024
    buffer_load_dwordx2 v[48:49], v8, s[48:51], s69 offen offset:2048
    s_cmp_ge_u32 s70, 5
    s_cbranch_scc1 L_nored0
    buffer_load_ushort v13, v12, s[40:43], 0 offen
    s_barrier
    s_mov_b32 s85, 100000
    buffer_load_dwordx4 v[64:67], v15, s[48:51], s72 offen sc1
    buffer_load_dwordx4 v[68:71], v15, s[48:51], s73 offen sc1
    buffer_load_dwordx4 v[72:75], v15, s[48:51], s74 offen sc1
    s_branch L_py_c
L_py:
    s_mov_b64 exec, s[4:5]
    buffer_load_dwordx4 v[64:67], v15, s[48:51], s72 offen sc1
    s_mov_b64 exec, s[6:7]
    buffer_load_dwordx4 v[68:71], v15, s[48:51], s73 offen sc1
    s_mov_b64 exec, s[8:9]
    buffer_load_dwordx4 v[72:75], v15, s[48:51], s74 offen sc1
    s_mov_b64 exec, -1
L_py_c:
    s_sub_u32 s85, s85, 1
    s_cbranch_scc1 L_py_t
    s_waitcnt vmcnt(2)
    v_max3_u32 v4, v64, v65, v66
    v_max_u32 v4, v4, v67
    v_cmp_eq_u32 s[4:5], -1, v4
    s_waitcnt vmcnt(1)
    v_max3_u32 v4, v68, v69, v70
    v_max_u32 v4, v4, v71
    v_cmp_eq_u32 s[6:7], -1, v4
    s_waitcnt vmcnt(0)
    v_max3_u32 v4, v72, v73, v74
    v_max_u32 v4, v4, v75
    v_cmp_eq_u32 s[8:9], -1, v4
    s_or_b64 vcc, s[4:5], s[6:7]
    s_or_b64 vcc, vcc, s[8:9]
    s_cbranch_scc1 L_py
L_py_x:
    v_lshlrev_b32 v13, 16, v13
    v_add_f32 v24, v64, v68
    v_add_f32 v25, v65, v69
    v_add_f32 v26, v66, v70
    v_add_f32 v27, v67, v71
    v_add_f32 v24, v24, v72
    v_add_f32 v25, v25, v73
    v_add_f32 v26, v26, v74
    v_add_f32 v27, v27, v75
    s_nop 0
    v_permlane32_swap_b32 v24, v26
    v_permlane32_swap_b32 v25, v27
    v_add_f32 v24, v24, v26
    v_add_f32 v25, v25, v27
    s_nop 1
    v_permlane16_swap_b32 v24, v25
    v_add_f32 v24, v24, v25
    s_nop 1
    v_add_f32_dpp v24, v24, v24 row_ror:8 row_mask:0xf bank_mask:0xf
    v_cvt_pk_bf16_f32 v24, 0, v24
    s_mov_b32 exec_lo, 0x00ff00ff
    s_mov_b32 exec_hi, 0x00ff00ff
    v_add_f32 v24, v13, v24
    v_cvt_pk_bf16_f32 v24, 0, v24
    s_cmp_eq_u32 s82, 1
    s_cbranch_scc0 L_pubh_g
    buffer_store_dword v24, v9, s[48:51], s75 offen
L_pubh_e:
    s_mov_b64 exec, -1
    s_add_u32 s72, s72, 515072
    s_add_u32 s73, s73, 515072
    s_add_u32 s74, s74, 515072
L_nored1:
    s_cmp_ge_u32 s71, 24
    s_cbranch_scc1 L_idle
    s_barrier
    s_mov_b32 s85, 100000
    buffer_load_dwordx4 v[40:43], v3, s[48:51], s69 offen sc1
    buffer_load_dwordx4 v[44:47], v3, s[48:51], s69 offen offset:1024 sc1
    buffer_load_dwordx2 v[48:49], v8, s[48:51], s69 offen offset:2048 sc1
    s_branch L_ph_c
L_ph:
    s_mov_b64 exec, s[4:5]
    buffer_load_dwordx4 v[40:43], v3, s[48:51], s69 offen sc1
    s_mov_b64 exec, s[6:7]
    buffer_load_dwordx4 v[44:47], v3, s[48:51], s69 offen offset:1024 sc1
    s_mov_b64 exec, s[8:9]
    buffer_load_dwordx2 v[48:49], v8, s[48:51], s69 offen offset:2048 sc1
    s_mov_b64 exec, -1
L_ph_c:
    s_sub_u32 s85, s85, 1
    s_cbranch_scc1 L_ph_t
    s_waitcnt vmcnt(2)
    v_max3_u32 v4, v40, v41, v42
    v_max_u32 v4, v4, v43
    v_cmp_eq_u32 s[4:5], -1, v4
    s_waitcnt vmcnt(1)
    v_max3_u32 v4, v44, v45, v46
    v_max_u32 v4, v4, v47
    v_cmp_eq_u32 s[6:7], -1, v4
    s_waitcnt vmcnt(0)
    v_max_u32 v4, v48, v49
    v_cmp_eq_u32 s[8:9], -1, v4
    s_or_b64 vcc, s[4:5], s[6:7]
    s_or_b64 vcc, vcc, s[8:9]
    s_cbranch_scc1 L_ph
L_ph_x:
    s_cmp_ge_u32 s70, 5
    s_cbranch_scc1 L_nopf
    buffer_load_dwordx4 v[64:67], v15, s[48:51], s72 offen
    buffer_load_dwordx4 v[68:71], v15, s[48:51], s73 offen
    buffer_load_dwordx4 v[72:75], v15, s[48:51], s74 offen
L_nopf:
    v_add_f32 v60, v40, v41
    v_add_f32 v61, v42, v43
    v_add_f32 v62, v44, v45
    v_add_f32 v63, v46, v47
    v_add_f32 v60, v60, v61
    v_add_f32 v62, v62, v63
    v_add_f32 v61, v48, v49
    v_add_f32 v60, v60, v62
    v_add_f32 v60, v60, v61
    s_nop 1
    v_add_f32_dpp v60, v60, v60 quad_perm:[1,0,3,2] row_mask:0xf bank_mask:0xf
    s_nop 1
    v_add_f32_dpp v60, v60, v60 quad_perm:[2,3,0,1] row_mask:0xf bank_mask:0xf
    s_nop 1
    v_add_f32_dpp v60, v60, v60 row_half_mirror row_mask:0xf bank_mask:0xf
    s_nop 1
    v_add_f32_dpp v60, v60, v60 row_ror:8 row_mask:0xf bank_mask:0xf
    v_mov_b32 v61, v60
    s_nop 1
    v_permlane16_swap_b32 v60, v61
    v_add_f32 v60, v60, v61
    v_mov_b32 v61, v60
    s_nop 1
    v_permlane32_swap_b32 v60, v61
    v_add_f32 v60, v60, v61
    v_mul_f32 v63, 0x3acccccd, v60
    v_cvt_pk_bf16_f32 v60, 0, v63
    v_sub_f32 v50, v40, v60
    v_sub_f32 v51, v41, v60
    v_sub_f32 v52, v42, v60
    v_sub_f32 v53, v43, v60
    v_sub_f32 v54, v44, v60
    v_sub_f32 v55, v45, v60
    v_sub_f32 v56, v46, v60
    v_sub_f32 v57, v47, v60
    v_sub_f32 v58, v48, v60
    v_sub_f32 v59, v49, v60
    v_mul_f32 v61, v50, v50
    v_mul_f32 v62, v51, v51
    v_fmac_f32 v61, v52, v52
    v_fmac_f32 v62, v53, v53
    v_fmac_f32 v61, v54, v54
    v_fmac_f32 v62, v55, v55
    v_fmac_f32 v61, v56, v56
    v_fmac_f32 v62, v57, v57
    v_fmac_f32 v61, v58, v58
    v_fmac_f32 v62, v59, v59
    v_add_f32 v61, v61, v62
    v_sub_f32 v63, v63, v60
    v_mul_f32 v63, v63, v63
    v_add_f32_dpp v61, v61, v61 quad_perm:[1,0,3,2] row_mask:0xf bank_mask:0xf
    v_cvt_pk_bf16_f32 v50, 0, v50
    v_cvt_pk_bf16_f32 v51, 0, v51
    v_add_f32_dpp v61, v61, v61 quad_perm:[2,3,0,1] row_mask:0xf bank_mask:0xf
    v_cvt_pk_bf16_f32 v52, 0, v52
    v_cvt_pk_bf16_f32 v53, 0, v53
    v_add_f32_dpp v61, v61, v61 row_half_mirror row_mask:0xf bank_mask:0xf
    v_cvt_pk_bf16_f32 v54, 0, v54
    v_cvt_pk_bf16_f32 v55, 0, v55
    v_add_f32_dpp v61, v61, v61 row_ror:8 row_mask:0xf bank_mask:0xf
    v_mov_b32 v62, v61
    v_cvt_pk_bf16_f32 v56, 0, v56
    v_cvt_pk_bf16_f32 v57, 0, v57
    v_permlane16_swap_b32 v61, v62
    v_add_f32 v61, v61, v62
    v_mov_b32 v62, v61
    v_cvt_pk_bf16_f32 v58, 0, v58
    v_cvt_pk_bf16_f32 v59, 0, v59
    v_permlane32_swap_b32 v61, v62
    v_add_f32 v61, v61, v62
    v_mul_f32 v61, 0x3acccccd, v61
    v_sub_f32 v61, v61, v63
    v_max_f32 v61, 0, v61
    v_cvt_pk_bf16_f32 v61, 0, v61
    v_add_f32 v61, 0x3727c5ac, v61
    v_cvt_pk_bf16_f32 v61, 0, v61
    v_sqrt_f32 v61, v61
    s_nop 0
    v_cvt_pk_bf16_f32 v61, 0, v61
    v_rcp_f32 v61, v61
    s_nop 0
    v_mul_f32 v50, v50, v61
    v_mul_f32 v51, v51, v61
    v_mul_f32 v52, v52, v61
    v_mul_f32 v53, v53, v61
    v_mul_f32 v54, v54, v61
    v_mul_f32 v55, v55, v61
    v_mul_f32 v56, v56, v61
    v_mul_f32 v57, v57, v61
    v_mul_f32 v58, v58, v61
    v_mul_f32 v59, v59, v61
    v_cvt_pk_bf16_f32 v32, v50, v51
    v_cvt_pk_bf16_f32 v33, v52, v53
    v_cvt_pk_bf16_f32 v34, v54, v55
    v_cvt_pk_bf16_f32 v35, v56, v57
    v_cvt_pk_bf16_f32 v36, v58, v59
    ds_write_b64 v10, v[32:33] offset:0
    ds_write_b64 v10, v[34:35] offset:4096
    ds_write_b32 v11, v36 offset:8192
    s_waitcnt lgkmcnt(0)
    s_barrier
    ds_read_b128 v[76:79], v5 offset:0
    ds_read_b128 v[80:83], v5 offset:1024
    ds_read_b128 v[84:87], v5 offset:2048
    ds_read_b128 v[88:91], v5 offset:3072
    ds_read_b128 v[92:95], v5 offset:4096
    ds_read_b128 v[96:99], v5 offset:5120
    ds_read_b128 v[100:103], v5 offset:6144
    ds_read_b128 v[104:107], v5 offset:7168
    ds_read_b128 v[108:111], v5 offset:8192
    ds_read_b128 v[112:115], v5 offset:9216
    buffer_load_dword v14, v19, s[48:51], 0 offen sc1
    s_waitcnt lgkmcnt(9)
    v_mfma_f32_16x16x32_bf16 v[116:119], v[76:79], v[176:179], 0
    s_waitcnt lgkmcnt(8)
    v_mfma_f32_16x16x32_bf16 v[116:119], v[80:83], v[180:183], v[116:119]
    s_waitcnt lgkmcnt(7)
    v_mfma_f32_16x16x32_bf16 v[116:119], v[84:87], v[184:187], v[116:119]
    s_waitcnt lgkmcnt(6)
    v_mfma_f32_16x16x32_bf16 v[116:119], v[88:91], v[188:191], v[116:119]
    s_waitcnt lgkmcnt(5)
    v_mfma_f32_16x16x32_bf16 v[116:119], v[92:95], v[192:195], v[116:119]
    s_waitcnt lgkmcnt(4)
    v_mfma_f32_16x16x32_bf16 v[116:119], v[96:99], v[196:199], v[116:119]
    s_waitcnt lgkmcnt(3)
    v_mfma_f32_16x16x32_bf16 v[116:119], v[100:103], v[200:203], v[116:119]
    s_waitcnt lgkmcnt(2)
    v_mfma_f32_16x16x32_bf16 v[116:119], v[104:107], v[204:207], v[116:119]
    s_waitcnt lgkmcnt(1)
    v_mfma_f32_16x16x32_bf16 v[116:119], v[108:111], v[208:211], v[116:119]
    s_waitcnt lgkmcnt(0)
    v_mfma_f32_16x16x32_bf16 v[116:119], v[112:115], v[212:215], v[116:119]
    s_nop 7
    v_permlane32_swap_b32 v116, v118
    v_permlane32_swap_b32 v117, v119
    s_nop 0
    v_add_f32_dpp v136, v118, v116 row_ror:8 row_mask:0xf bank_mask:0x3
    s_nop 1
    v_add_f32_dpp v136, v117, v119 row_ror:8 row_mask:0xf bank_mask:0xc
    v_cvt_pk_bf16_f32 v136, 0, v136
    v_mul_f32 v137, 0xbfb8aa3b, v136
    v_exp_f32 v137, v137
    s_nop 0
    v_add_f32 v137, 1.0, v137
    v_rcp_f32 v137, v137
    s_nop 0
    v_mul_f32 v136, v136, v137
    v_cvt_pk_bf16_f32 v136, v136, v136
    ds_write_b16 v16, v136 offset:23136
    s_mov_b32 exec_lo, 0x00ff00ff
    s_mov_b32 exec_hi, 0x00ff00ff
    s_waitcnt lgkmcnt(0)
    s_barrier
    ds_read_b128 v[120:123], v7 offset:23136
    ds_read_b128 v[124:127], v7 offset:23200
    s_not_b64 exec, exec
    ds_read_b128 v[128:131], v7 offset:23136
    ds_read_b128 v[132:135], v7 offset:23200
    s_mov_b64 exec, -1
    s_cmp_eq_u32 s82, 1
    s_cbranch_scc0 L_f2g
    s_cmp_eq_u32 s77, 0
    s_waitcnt lgkmcnt(3)
    v_mfma_f32_16x16x32_bf16 v[76:79], v[216:219], v[120:123], 0
    s_waitcnt lgkmcnt(2)
    v_mfma_f32_16x16x32_bf16 v[76:79], v[220:223], v[124:127], v[76:79]
    s_waitcnt lgkmcnt(1)
    v_mfma_f32_16x16x32_bf16 v[76:79], v[224:227], v[128:131], v[76:79]
    s_waitcnt lgkmcnt(0)
    v_mfma_f32_16x16x32_bf16 v[76:79], v[228:231], v[132:135], v[76:79]
    v_mfma_f32_16x16x32_bf16 v[80:83], v[232:235], v[120:123], 0
    v_mfma_f32_16x16x32_bf16 v[80:83], v[236:239], v[124:127], v[80:83]
    v_mfma_f32_16x16x32_bf16 v[80:83], v[240:243], v[128:131], v[80:83]
    v_mfma_f32_16x16x32_bf16 v[80:83], v[244:247], v[132:135], v[80:83]
    s_cbranch_scc1 L_no3b
    v_mfma_f32_16x16x32_bf16 v[84:87], v[160:163], v[120:123], 0
    v_mfma_f32_16x16x32_bf16 v[84:87], v[164:167], v[124:127], v[84:87]
    v_mfma_f32_16x16x32_bf16 v[84:87], v[168:171], v[128:131], v[84:87]
    buffer_store_dwordx4 v[76:79], v3, s[48:51], s76 offen offset:0
    v_mfma_f32_16x16x32_bf16 v[84:87], v[172:175], v[132:135], v[84:87]
    s_nop 1
    buffer_store_dwordx4 v[80:83], v3, s[48:51], s76 offen offset:2048
    s_nop 4
    buffer_store_dwordx4 v[84:87], v3, s[48:51], s68 offen offset:0
    s_branch L_no3c
L_no3b:
    s_nop 2
    buffer_store_dwordx4 v[76:79], v3, s[48:51], s76 offen offset:0
    s_nop 2
    buffer_store_dwordx4 v[80:83], v3, s[48:51], s76 offen offset:2048
L_no3c:
L_noffn:
    s_cmp_ge_u32 s70, 5
    s_cbranch_scc1 L_done
    s_mov_b32 s85, 100000
    buffer_load_dwordx4 v[64:67], v15, s[48:51], s72 offen sc1
    buffer_load_dwordx4 v[68:71], v15, s[48:51], s73 offen sc1
    buffer_load_dwordx4 v[72:75], v15, s[48:51], s74 offen sc1
    s_branch L_pf_c
L_pf:
    s_mov_b64 exec, s[4:5]
    buffer_load_dwordx4 v[64:67], v15, s[48:51], s72 offen sc1
    s_mov_b64 exec, s[6:7]
    buffer_load_dwordx4 v[68:71], v15, s[48:51], s73 offen sc1
    s_mov_b64 exec, s[8:9]
    buffer_load_dwordx4 v[72:75], v15, s[48:51], s74 offen sc1
    s_mov_b64 exec, -1
L_pf_c:
    s_sub_u32 s85, s85, 1
    s_cbranch_scc1 L_pf_t
    s_waitcnt vmcnt(2)
    v_max3_u32 v4, v64, v65, v66
    v_max_u32 v4, v4, v67
    v_cmp_eq_u32 s[4:5], -1, v4
    s_waitcnt vmcnt(1)
    v_max3_u32 v4, v68, v69, v70
    v_max_u32 v4, v4, v71
    v_cmp_eq_u32 s[6:7], -1, v4
    s_waitcnt vmcnt(0)
    v_max3_u32 v4, v72, v73, v74
    v_max_u32 v4, v4, v75
    v_cmp_eq_u32 s[8:9], -1, v4
    s_or_b64 vcc, s[4:5], s[6:7]
    s_or_b64 vcc, vcc, s[8:9]
    s_cbranch_scc1 L_pf
L_pf_x:
    v_add_f32 v24, v64, v68
    v_add_f32 v25, v65, v69
    v_add_f32 v26, v66, v70
    v_add_f32 v27, v67, v71
    v_add_f32 v24, v24, v72
    v_add_f32 v25, v25, v73
    v_add_f32 v26, v26, v74
    v_add_f32 v27, v27, v75
    s_nop 0
    v_permlane32_swap_b32 v24, v26
    v_permlane32_swap_b32 v25, v27
    v_add_f32 v24, v24, v26
    v_add_f32 v25, v25, v27
    s_nop 1
    v_permlane16_swap_b32 v24, v25
    v_add_f32 v24, v24, v25
    s_nop 1
    v_add_f32_dpp v24, v24, v24 row_ror:8 row_mask:0xf bank_mask:0xf
    v_cvt_pk_bf16_f32 v24, 0, v24
    s_mov_b32 exec_lo, 0x00ff00ff
    s_mov_b32 exec_hi, 0x00ff00ff
    v_add_f32 v14, v14, v24
    v_cvt_pk_bf16_f32 v14, v14, v14
    buffer_store_short v14, v18, s[56:59], 0 offen
L_done:
L_end:
    s_endpgm
L_pq_late:
    s_cmp_eq_u32 s73, 0
    s_cbranch_scc0 L_pq_x
    s_mov_b32 s73, 1
    s_mov_b32 s85, 100000
    s_mov_b64 exec, s[74:75]
    s_cbranch_execz L_qp1
    buffer_store_dwordx4 v[64:67], v3, s[48:51], s67 offen offset:0 sc1
    buffer_store_dwordx4 v[68:71], v3, s[48:51], s67 offen offset:1024 sc1
L_qp1:
    s_mov_b64 exec, 1
    buffer_store_dword v12, v3, s[48:51], s66 offen sc1
    s_mov_b64 exec, -1
    s_branch L_pq
L_pq_far:
    s_mov_b64 exec, s[74:75]
    s_cbranch_execz L_qp2
    buffer_store_dwordx4 v[64:67], v3, s[48:51], s67 offen offset:0 sc1
    buffer_store_dwordx4 v[68:71], v3, s[48:51], s67 offen offset:1024 sc1
L_qp2:
    s_mov_b64 exec, 1
    buffer_store_dword v12, v3, s[48:51], s66 offen sc1
    s_mov_b64 exec, -1
    s_branch L_pq_done
L_pubo_g:
    buffer_store_dword v24, v174, s[48:51], s69 offen offset:0 sc1
    s_branch L_pubo_e
L_po_t:
    s_waitcnt vmcnt(0)
    s_branch L_po_x
L_py_t:
    s_waitcnt vmcnt(0)
    s_branch L_py_x
L_pubh_g:
    buffer_store_dword v24, v9, s[48:51], s75 offen sc1
    s_branch L_pubh_e
L_nored0:
    s_cmp_eq_u32 s70, 8
    s_cbranch_scc1 L_nored1
    s_barrier
    s_branch L_nored1
L_idle:
    s_cmp_ge_u32 s70, 5
    s_cbranch_scc1 L_done
    s_mov_b32 s85, 100000
L_ph2:
    buffer_load_dword v14, v19, s[48:51], 0 offen sc1
    s_sub_u32 s85, s85, 1
    s_waitcnt vmcnt(0)
    s_cbranch_scc1 L_ph2_x
    v_cmp_eq_u32 vcc, -1, v14
    s_cbranch_vccnz L_ph2
L_ph2_x:
    s_branch L_noffn
L_ph_t:
    s_waitcnt vmcnt(0)
    s_branch L_ph_x
L_f2g:
    s_cmp_eq_u32 s77, 0
    s_waitcnt lgkmcnt(3)
    v_mfma_f32_16x16x32_bf16 v[76:79], v[216:219], v[120:123], 0
    s_waitcnt lgkmcnt(2)
    v_mfma_f32_16x16x32_bf16 v[76:79], v[220:223], v[124:127], v[76:79]
    s_waitcnt lgkmcnt(1)
    v_mfma_f32_16x16x32_bf16 v[76:79], v[224:227], v[128:131], v[76:79]
    s_waitcnt lgkmcnt(0)
    v_mfma_f32_16x16x32_bf16 v[76:79], v[228:231], v[132:135], v[76:79]
    v_mfma_f32_16x16x32_bf16 v[80:83], v[232:235], v[120:123], 0
    v_mfma_f32_16x16x32_bf16 v[80:83], v[236:239], v[124:127], v[80:83]
    v_mfma_f32_16x16x32_bf16 v[80:83], v[240:243], v[128:131], v[80:83]
    v_mfma_f32_16x16x32_bf16 v[80:83], v[244:247], v[132:135], v[80:83]
    s_cbranch_scc1 L_no3g
    v_mfma_f32_16x16x32_bf16 v[84:87], v[160:163], v[120:123], 0
    v_mfma_f32_16x16x32_bf16 v[84:87], v[164:167], v[124:127], v[84:87]
    v_mfma_f32_16x16x32_bf16 v[84:87], v[168:171], v[128:131], v[84:87]
    buffer_store_dwordx4 v[76:79], v3, s[48:51], s76 offen offset:0 sc1
    v_mfma_f32_16x16x32_bf16 v[84:87], v[172:175], v[132:135], v[84:87]
    s_nop 1
    buffer_store_dwordx4 v[80:83], v3, s[48:51], s76 offen offset:2048 sc1
    s_nop 4
    buffer_store_dwordx4 v[84:87], v3, s[48:51], s68 offen offset:0 sc1
    s_branch L_no3c
L_no3g:
    s_nop 2
    buffer_store_dwordx4 v[76:79], v3, s[48:51], s76 offen offset:0 sc1
    s_nop 2
    buffer_store_dwordx4 v[80:83], v3, s[48:51], s76 offen offset:2048 sc1
    s_branch L_no3c
L_pf_t:
    s_waitcnt vmcnt(0)
    s_branch L_pf_x
L_last:
    s_endpgm
.section .rodata,"a"
.p2align 6
.amdhsa_kernel sequential_preLN__sliding_block_cached__dense_activation_silu__decode_kernel
  .amdhsa_next_free_vgpr 256
  .amdhsa_next_free_sgpr 102
  .amdhsa_accum_offset 256
  .amdhsa_group_segment_fixed_size 0
  .amdhsa_kernarg_size 88
  .amdhsa_user_sgpr_count 2
  .amdhsa_user_sgpr_kernarg_segment_ptr 1
  .amdhsa_system_sgpr_workgroup_id_x 1
  .amdhsa_float_denorm_mode_32 3
.end_amdhsa_kernel
```
